```python
import torch

def _softmax(x, axis=-1):
    return torch.softmax(x, dim=axis)
def _gelu(x):
    return torch.nn.functional.gelu(x, approximate="tanh")
def _silu(x):
    return torch.nn.functional.silu(x)
def _sigmoid(x):
    return torch.sigmoid(x)
def _layernorm(x, axis=-1, eps=1e-5):
    m = x.mean(dim=axis, keepdim=True)
    v = x.var(dim=axis, keepdim=True, unbiased=False)
    return (x - m) / torch.sqrt(v + eps)
def _scatter_add(tgt, idx, src, axis=0):
    return tgt.clone().index_add_(axis, idx, src)
def _segment_sum(src, seg, n):
    out = torch.zeros((n,) + src.shape[1:], dtype=src.dtype)
    return out.index_add_(0, seg, src)
def _pad(x, pw):
    flat = tuple(v for pair in reversed(pw) for v in pair)
    return torch.nn.functional.pad(x, flat)

kernel_name = 'sequential_preLN__gqa_block_cached__geglu_ffn__decode'

def setup_inputs():

    _w = (lambda a: (lambda t: t.to(torch.bfloat16) if t.is_floating_point() else t)(torch.as_tensor(a)))
    def _A_setup():
        B, Sq, D = 2, 1, 448
        Hq, Hkv, Sk, Dh = 16, 8, 8192, 256
        assert Hq % Hkv == 0, (Hq, Hkv)
        return {
            "x": _w((lambda *s: torch.randn(*s, dtype=torch.bfloat16) * 0.05)(B, Sq, D)),
            "k_cache": _w((lambda *s: torch.randn(*s, dtype=torch.bfloat16) * 3.2)(B, Hkv, Sk, Dh)),
            "v_cache": _w((lambda *s: torch.randn(*s, dtype=torch.bfloat16) * 0.4)(B, Hkv, Sk, Dh)),
            "wq": _w((lambda *s: torch.randn(*s, dtype=torch.bfloat16) * 3.2)(D, Hq * Dh) * (D ** -0.5)),
            "wo": _w((lambda *s: torch.randn(*s, dtype=torch.bfloat16) * 0.4)(Hq * Dh, D) * ((Hq * Dh) ** -0.5)),
        }
    _A_in = _A_setup()

    def _B_setup():
        B, S, D, F = 2, 1, 448, 1792
        return {
            "x": _w((lambda *s: torch.randn(*s, dtype=torch.bfloat16) * 0.05)(B, S, D)),
            "w_gate": _w((lambda *s: torch.randn(*s, dtype=torch.bfloat16) * 0.05)(D, F)),
            "w_up": _w((lambda *s: torch.randn(*s, dtype=torch.bfloat16) * 0.05)(D, F)),
            "w_down": _w((lambda *s: torch.randn(*s, dtype=torch.bfloat16) * 0.05)(F, D)),
        }
    _B_in = _B_setup()

    return {
        "A_x": _A_in["x"],
        "A_k_cache": _A_in["k_cache"],
        "A_v_cache": _A_in["v_cache"],
        "A_wq": _A_in["wq"],
        "A_wo": _A_in["wo"],
        "B_x": _B_in["x"],
        "B_w_gate": _B_in["w_gate"],
        "B_w_up": _B_in["w_up"],
        "B_w_down": _B_in["w_down"],
    }

def reference(A_x, A_k_cache, A_v_cache, A_wq, A_wo, B_x, B_w_gate, B_w_up, B_w_down):
    def _A_ref(x, k_cache, v_cache, wq, wo):
        B, Sq, D = x.shape
        Hq, Dh = 16, 256
        Hkv = k_cache.shape[1]
        rep = Hq // Hkv
        q = (lambda x, *d: x.permute(*d))((x @ wq).reshape(B, Sq, Hq, Dh), 0, 2, 1, 3)
        k = (lambda x, n, axis: torch.repeat_interleave(x, n, dim=axis))(k_cache, rep, axis=1)
        v = (lambda x, n, axis: torch.repeat_interleave(x, n, dim=axis))(v_cache, rep, axis=1)
        scores = torch.einsum("bhqd,bhkd->bhqk", q, k) * (Dh ** -0.5)
        p = _softmax(scores, axis=-1)
        o = torch.einsum("bhqk,bhkd->bhqd", p, v)
        return (lambda x, *d: x.permute(*d))(o, 0, 2, 1, 3).reshape(B, Sq, Hq * Dh) @ wo

    def _B_ref(x, w_gate, w_up, w_down):
        return (_gelu(x @ w_gate) * (x @ w_up)) @ w_down

    x = A_x
    h = x + _A_ref(_layernorm(x, axis=-1), A_k_cache, A_v_cache, A_wq, A_wo)
    h2 = h + _B_ref(_layernorm(h, axis=-1), B_w_gate, B_w_up, B_w_down)
    return h2
```

```asm
; @launch grid=(256,1,1) block=(512,1,1) lds=156672
.amdgcn_target "amdgcn-amd-amdhsa--gfx950"
.text
.globl sequential_preLN__gqa_block_cached__geglu_ffn__decode_kernel
.p2align 8
.type sequential_preLN__gqa_block_cached__geglu_ffn__decode_kernel,@function
sequential_preLN__gqa_block_cached__geglu_ffn__decode_kernel:
    s_cmp_ge_u32 s2, 256
    s_cbranch_scc1 L_end
    s_load_dwordx16 s[4:19], s[0:1], 0
    s_load_dwordx8 s[20:27], s[0:1], 64
    v_lshrrev_b32 v1, 6, v0
    v_and_b32 v0, 63, v0
    v_readfirstlane_b32 s3, v1
    s_and_b32 s32, s2, 15
    s_lshr_b32 s33, s2, 4
    s_lshr_b32 s34, s32, 3
    s_and_b32 s35, s32, 7
    v_mov_b32 v3, 131072
    s_mov_b32 s64, 4194304
    s_cmp_ge_u32 s33, 12
    s_cbranch_scc1 L_service
    s_mul_i32 s65, s33, 43691
    s_add_u32 s66, s65, 43691
    s_lshr_b32 s65, s65, 6
    s_lshr_b32 s66, s66, 6
    s_cmp_lg_u32 s3, 1
    s_cbranch_scc1 L_notloader
    s_setprio 3
    v_lshrrev_b32 v1, 5, v0
    v_and_b32 v2, 31, v0
    v_xor_b32 v4, v2, v1
    v_lshlrev_b32 v4, 4, v4
    v_lshl_or_b32 v8, v1, 9, v4
    v_xor_b32 v9, 32, v8
    v_xor_b32 v10, 64, v8
    v_xor_b32 v11, 96, v8
    v_xor_b32 v12, 128, v8
    v_xor_b32 v13, 160, v8
    v_xor_b32 v14, 192, v8
    v_xor_b32 v15, 224, v8
    v_lshlrev_b32 v4, 1, v1
    v_xor_b32 v4, v2, v4
    v_lshlrev_b32 v4, 4, v4
    v_lshl_or_b32 v16, v1, 9, v4
    v_xor_b32 v17, 64, v16
    v_xor_b32 v18, 128, v16
    v_xor_b32 v19, 192, v16
    s_lshl_b32 s45, s32, 22
    s_lshl_b32 s44, s65, 9
    s_add_u32 s44, s44, s45
    s_lshl_b32 s38, s66, 9
    s_add_u32 s38, s38, s45
    s_mov_b32 s45, s44
    s_mov_b32 s46, 0
    s_mov_b32 s47, -6
    s_mov_b32 s48, 0
    s_mov_b32 s50, 2
    s_mov_b32 m0, 0
    s_mov_b32 s39, 0x20000
    s_waitcnt lgkmcnt(0)
    s_mov_b32 s36, s6
    s_mov_b32 s37, s7
    s_mov_b32 s40, s8
    s_mov_b32 s41, s9
    s_mov_b32 s42, s38
    s_mov_b32 s43, 0x20000
L_slot:
    s_add_u32 s56, s47, 8
    s_cmp_lt_u32 s46, s56
    s_cbranch_scc0 L_waitfree
L_go:
    s_cmp_ge_u32 s46, 22
    s_cbranch_scc1 L_go2
    s_waitcnt vmcnt(24)
    buffer_load_dwordx4 v8, s[36:39], s45 offen offset:0 nt lds
    buffer_load_dwordx4 v9, s[36:39], s45 offen offset:1024 nt lds
    buffer_load_dwordx4 v10, s[36:39], s45 offen offset:2048 nt lds
    buffer_load_dwordx4 v11, s[36:39], s45 offen offset:3072 nt lds
    s_add_u32 m0, m0, 4096
    s_add_u32 s45, s45, 4096
    buffer_load_dwordx4 v12, s[36:39], s45 offen offset:0 nt lds
    buffer_load_dwordx4 v13, s[36:39], s45 offen offset:1024 nt lds
    buffer_load_dwordx4 v14, s[36:39], s45 offen offset:2048 nt lds
    buffer_load_dwordx4 v15, s[36:39], s45 offen offset:3072 nt lds
    s_add_u32 m0, m0, 4096
    s_add_u32 s45, s45, 4096
    s_waitcnt vmcnt(24)
    s_sub_i32 s56, s46, 1
    s_max_i32 s48, s48, s56
    v_mov_b32 v20, s48
    ds_write_b32 v3, v20 offset:4816
    buffer_load_dwordx4 v8, s[36:39], s45 offen offset:0 nt lds
    buffer_load_dwordx4 v9, s[36:39], s45 offen offset:1024 nt lds
    buffer_load_dwordx4 v10, s[36:39], s45 offen offset:2048 nt lds
    buffer_load_dwordx4 v11, s[36:39], s45 offen offset:3072 nt lds
    s_add_u32 m0, m0, 4096
    s_add_u32 s45, s45, 4096
    buffer_load_dwordx4 v12, s[36:39], s45 offen offset:0 nt lds
    buffer_load_dwordx4 v13, s[36:39], s45 offen offset:1024 nt lds
    buffer_load_dwordx4 v14, s[36:39], s45 offen offset:2048 nt lds
    buffer_load_dwordx4 v15, s[36:39], s45 offen offset:3072 nt lds
    s_add_u32 m0, m0, 4096
    s_add_u32 s45, s45, 4096
    s_branch L_go3
L_go2:
    s_waitcnt vmcnt(40)
    buffer_load_dwordx4 v16, s[40:43], s44 offen offset:0 nt lds
    buffer_load_dwordx4 v17, s[40:43], s44 offen offset:1024 nt lds
    buffer_load_dwordx4 v18, s[40:43], s44 offen offset:2048 nt lds
    buffer_load_dwordx4 v19, s[40:43], s44 offen offset:3072 nt lds
    s_add_u32 m0, m0, 4096
    s_add_u32 s44, s44, 4096
    buffer_load_dwordx4 v16, s[40:43], s44 offen offset:0 nt lds
    buffer_load_dwordx4 v17, s[40:43], s44 offen offset:1024 nt lds
    buffer_load_dwordx4 v18, s[40:43], s44 offen offset:2048 nt lds
    buffer_load_dwordx4 v19, s[40:43], s44 offen offset:3072 nt lds
    s_add_u32 m0, m0, 4096
    s_add_u32 s44, s44, 4096
    s_waitcnt vmcnt(40)
    s_sub_i32 s56, s46, 2
    s_max_i32 s48, s48, s56
    v_mov_b32 v20, s48
    ds_write_b32 v3, v20 offset:4816
    buffer_load_dwordx4 v16, s[40:43], s44 offen offset:0 nt lds
    buffer_load_dwordx4 v17, s[40:43], s44 offen offset:1024 nt lds
    buffer_load_dwordx4 v18, s[40:43], s44 offen offset:2048 nt lds
    buffer_load_dwordx4 v19, s[40:43], s44 offen offset:3072 nt lds
    s_add_u32 m0, m0, 4096
    s_add_u32 s44, s44, 4096
    buffer_load_dwordx4 v16, s[40:43], s44 offen offset:0 nt lds
    buffer_load_dwordx4 v17, s[40:43], s44 offen offset:1024 nt lds
    buffer_load_dwordx4 v18, s[40:43], s44 offen offset:2048 nt lds
    buffer_load_dwordx4 v19, s[40:43], s44 offen offset:3072 nt lds
    s_add_u32 m0, m0, 4096
    s_add_u32 s44, s44, 4096
L_go3:
    s_and_b32 m0, m0, 131071
    s_add_u32 s46, s46, 1
    s_cmp_lg_u32 s46, s50
    s_cbranch_scc1 L_slot
    s_cmp_lg_u32 s46, 2
    s_cbranch_scc1 L_ldone
    s_barrier
    s_mov_b32 s50, 44
    s_branch L_slot
L_ldone:
    s_waitcnt vmcnt(32)
    s_sub_i32 s56, s46, 2
    s_max_i32 s48, s48, s56
    v_mov_b32 v20, s48
    ds_write_b32 v3, v20 offset:4816
    s_waitcnt vmcnt(16)
    s_barrier
    s_waitcnt vmcnt(0)
    s_barrier
    s_endpgm
L_waitfree:
    ds_read_b128 v[20:23], v3 offset:4848
    ds_read_b64 v[24:25], v3 offset:4864
    s_waitcnt lgkmcnt(0)
    v_min3_u32 v20, v20, v21, v22
    v_min3_u32 v23, v23, v24, v25
    v_min_u32 v20, v20, v23
    s_nop 0
    v_readfirstlane_b32 s47, v20
    s_add_u32 s56, s47, 8
    s_cmp_lt_u32 s46, s56
    s_cbranch_scc1 L_go
    s_waitcnt vmcnt(32)
    s_sub_i32 s56, s46, 2
    s_max_i32 s48, s48, s56
    v_mov_b32 v20, s48
    ds_write_b32 v3, v20 offset:4816
    ds_read_b128 v[20:23], v3 offset:4848
    ds_read_b64 v[24:25], v3 offset:4864
    s_waitcnt lgkmcnt(0)
    v_min3_u32 v20, v20, v21, v22
    v_min3_u32 v23, v23, v24, v25
    v_min_u32 v20, v20, v23
    s_nop 0
    v_readfirstlane_b32 s47, v20
    s_add_u32 s56, s47, 8
    s_cmp_lt_u32 s46, s56
    s_cbranch_scc1 L_go
    s_waitcnt vmcnt(16)
    s_sub_i32 s56, s46, 1
    s_max_i32 s48, s48, s56
    v_mov_b32 v20, s48
    ds_write_b32 v3, v20 offset:4816
    ds_read_b128 v[20:23], v3 offset:4848
    ds_read_b64 v[24:25], v3 offset:4864
    s_waitcnt lgkmcnt(0)
    v_min3_u32 v20, v20, v21, v22
    v_min3_u32 v23, v23, v24, v25
    v_min_u32 v20, v20, v23
    s_nop 0
    v_readfirstlane_b32 s47, v20
    s_add_u32 s56, s47, 8
    s_cmp_lt_u32 s46, s56
    s_cbranch_scc1 L_go
    s_waitcnt vmcnt(0)
    s_sub_i32 s56, s46, 0
    s_max_i32 s48, s48, s56
    v_mov_b32 v20, s48
    ds_write_b32 v3, v20 offset:4816
L_wf2:
    ds_read_b128 v[20:23], v3 offset:4848
    ds_read_b64 v[24:25], v3 offset:4864
    s_waitcnt lgkmcnt(0)
    v_min3_u32 v20, v20, v21, v22
    v_min3_u32 v23, v23, v24, v25
    v_min_u32 v20, v20, v23
    s_nop 0
    v_readfirstlane_b32 s47, v20
    s_add_u32 s56, s47, 8
    s_cmp_lt_u32 s46, s56
    s_cbranch_scc1 L_go
    s_sleep 1
    s_sub_u32 s64, s64, 1
    s_cbranch_scc0 L_wf2
    s_mov_b32 s64, 0
    s_branch L_go
L_notloader:
    v_lshrrev_b32 v1, 4, v0
    v_and_b32 v2, 15, v0
    s_waitcnt lgkmcnt(0)
    s_load_dwordx4 s[28:31], s[26:27], 0
    s_mov_b32 s52, s26
    s_mov_b32 s53, s27
    s_mov_b32 s54, 1048576
    s_mov_b32 s55, 0x20000
    s_mov_b32 s58, 1023
    s_mov_b32 s59, 4294966272
    s_cmp_lg_u32 s3, 0
    s_cbranch_scc1 L_noinit
    v_mov_b32 v8, 0
    v_lshl_add_u32 v9, v0, 2, v3
    ds_write_b32 v9, v8 offset:4096
    s_mov_b64 exec, 0xff
    ds_write_b32 v9, v8 offset:4816
    ds_write_b32 v9, v0 offset:4848
    s_mov_b64 exec, 0x3
    v_mov_b32 v10, 0xff800000
    ds_write_b32 v9, v10 offset:4736
    s_mov_b64 exec, -1
L_noinit:
    s_sub_u32 s61, s3, 2
    s_waitcnt lgkmcnt(0)
    s_add_u32 s28, s28, 1
    s_and_b32 s28, s28, 1023
    v_mov_b32 v4, s28
    s_add_u32 s29, s29, 7
    s_and_b32 s29, s29, 1023
    v_mov_b32 v5, s29
    s_add_u32 s30, s30, 19
    s_and_b32 s30, s30, 1023
    v_mov_b32 v6, s30
    s_add_u32 s31, s31, 45
    s_and_b32 s31, s31, 1023
    v_mov_b32 v7, s31
    s_mov_b32 s48, 0
    s_barrier
    s_cmp_ge_u32 s3, 2
    s_cbranch_scc1 L_cons
    s_lshl_b32 s45, s34, 14
    s_lshl_b32 s46, s35, 11
    s_add_u32 s45, s45, s46
    s_add_u32 s45, s45, 4096
    v_lshlrev_b32 v16, 4, v0
    s_cmp_ge_u32 s48, 13
    s_cbranch_scc1 Lw_1
Lw_2:
    ds_read_b32 v17, v3 offset:4816
    s_waitcnt lgkmcnt(0)
    v_readfirstlane_b32 s48, v17
    s_cmp_ge_u32 s48, 13
    s_cbranch_scc1 Lw_1
    s_sleep 1
    s_sub_u32 s64, s64, 1
    s_cbranch_scc0 Lw_2
    s_mov_b32 s64, 0
Lw_1:
Lg_3:
    buffer_load_dwordx4 v[20:23], v16, s[52:55], s45 offen offset:0 sc1
    buffer_load_dwordx4 v[24:27], v16, s[52:55], s45 offen offset:1024 sc1
    s_waitcnt vmcnt(0)
    v_xor_b32 v20, s28, v20
    v_xor_b32 v21, s29, v21
    v_xor_b32 v22, s30, v22
    v_xor_b32 v23, s31, v23
    v_xor_b32 v24, s28, v24
    v_xor_b32 v25, s29, v25
    v_xor_b32 v26, s30, v26
    v_xor_b32 v27, s31, v27
    v_or3_b32 v17, v20, v21, v22
    v_or3_b32 v17, v17, v23, v24
    v_or3_b32 v17, v17, v25, v26
    v_bitop3_b32 v17, v17, v27, s58 bitop3:0xa8
    v_cmp_ne_u32 vcc, 0, v17
    s_cbranch_vccz Lg_4
    s_sleep 16
    s_sub_u32 s64, s64, 9
    s_cbranch_scc0 Lg_3
    s_mov_b32 s64, 0
Lg_4:
    s_mov_b32 s56, 0x07060302
    v_perm_b32 v28, v21, v20, s56
    v_perm_b32 v29, v23, v22, s56
    v_perm_b32 v30, v25, v24, s56
    v_perm_b32 v31, v27, v26, s56
    v_lshl_add_u32 v16, v0, 3, v3
    ds_write_b64 v16, v[28:29] offset:0
    ds_write_b64 v16, v[30:31] offset:512
    s_getreg_b32 s56, hwreg(HW_REG_XCC_ID)
    s_and_b32 s56, s56, 15
    v_bfe_u32 v18, v20, 10, 4
    v_bfe_u32 v19, v24, 10, 4
    v_cmp_ne_u32 vcc, s56, v18
    v_cmp_ne_u32 s[44:45], s56, v19
    s_nop 0
    s_or_b64 vcc, vcc, s[44:45]
    s_cselect_b32 s67, 1, 2
    v_mov_b32 v17, s67
    ds_write_b32 v3, v17 offset:4820
Lw_6:
    ds_read_b32 v8, v3 offset:4828
    s_waitcnt lgkmcnt(0)
    v_readfirstlane_b32 s47, v8
    s_cmp_ge_u32 s47, 6
    s_cbranch_scc1 Lw_5
    s_sleep 4
    s_sub_u32 s64, s64, 3
    s_cbranch_scc0 Lw_6
    s_mov_b32 s64, 0
Lw_5:
    ds_read_b32 v10, v9 offset:4096
    ds_read_b64 v[12:13], v3 offset:4736
    s_waitcnt lgkmcnt(0)
    v_add_f32_dpp v10, v10, v10 row_ror:1 row_mask:0xf bank_mask:0xf
    s_nop 1
    v_add_f32_dpp v10, v10, v10 row_ror:2 row_mask:0xf bank_mask:0xf
    s_nop 1
    v_add_f32_dpp v10, v10, v10 row_ror:4 row_mask:0xf bank_mask:0xf
    s_nop 1
    v_add_f32_dpp v10, v10, v10 row_ror:8 row_mask:0xf bank_mask:0xf
    s_nop 1
    v_readlane_b32 s56, v10, 16
    v_readlane_b32 s57, v10, 32
    v_readlane_b32 s60, v10, 48
    s_nop 0
    v_add_f32 v14, s56, v10
    v_mov_b32 v15, s57
    v_add_f32 v15, s60, v15
    v_and_or_b32 v12, v12, s59, v4
    v_and_or_b32 v13, v13, s59, v5
    v_and_or_b32 v14, v14, s59, v6
    v_and_or_b32 v15, v15, s59, v7
    s_lshl_b32 s45, s32, 11
    s_add_u32 s45, s45, 98304
    s_lshl_b32 s46, s33, 7
    v_mov_b32 v9, s46
    s_mov_b64 exec, 1
    s_cmp_eq_u32 s67, 2
    s_cbranch_scc1 L_mlfast
    buffer_store_dwordx4 v[12:15], v9, s[52:55], s45 offen sc1
    s_branch L_mldone
L_mlfast:
    buffer_store_dwordx4 v[12:15], v9, s[52:55], s45 offen
L_mldone:
    s_endpgm
L_cons:
    v_xor_b32 v12, v1, v2
    v_lshlrev_b32 v12, 4, v12
    v_lshl_or_b32 v8, v2, 9, v12
    v_xor_b32 v9, 64, v8
    v_xor_b32 v10, 128, v8
    v_xor_b32 v11, 192, v8
    s_add_u32 s46, s61, 1
    s_lshl_b32 s44, s61, 14
    s_lshl_b32 s62, s61, 2
    v_add_u32 v13, s62, v3
    v_add_u32 v244, s44, v8
    v_add_u32 v245, s44, v9
    v_add_u32 v246, s44, v10
    v_add_u32 v247, s44, v11
    s_cmp_ge_u32 s48, s46
    s_cbranch_scc1 Lw_7
Lw_8:
    ds_read_b32 v12, v3 offset:4816
    s_waitcnt lgkmcnt(0)
    v_readfirstlane_b32 s48, v12
    s_cmp_ge_u32 s48, s46
    s_cbranch_scc1 Lw_7
    s_sleep 1
    s_sub_u32 s64, s64, 1
    s_cbranch_scc0 Lw_8
    s_mov_b32 s64, 0
Lw_7:
    ds_read_b128 v[16:19], v244 offset:0
    ds_read_b128 v[20:23], v245 offset:0
    ds_read_b128 v[24:27], v246 offset:0
    ds_read_b128 v[28:31], v247 offset:0
    ds_read_b128 v[32:35], v244 offset:256
    ds_read_b128 v[36:39], v245 offset:256
    ds_read_b128 v[40:43], v246 offset:256
    ds_read_b128 v[44:47], v247 offset:256
    ds_read_b128 v[48:51], v244 offset:8192
    ds_read_b128 v[52:55], v245 offset:8192
    ds_read_b128 v[56:59], v246 offset:8192
    ds_read_b128 v[60:63], v247 offset:8192
    ds_read_b128 v[64:67], v244 offset:8448
    ds_read_b128 v[68:71], v245 offset:8448
    ds_read_b128 v[72:75], v246 offset:8448
    ds_read_b128 v[76:79], v247 offset:8448
    s_add_u32 s56, s46, 5
    s_min_u32 s56, s56, 22
    v_mov_b32 v12, s56
    s_add_u32 s46, s46, 6
    s_add_u32 s44, s44, 98304
    s_and_b32 s44, s44, 131071
    s_waitcnt lgkmcnt(0)
    ds_write_b32 v13, v12 offset:4848
    v_add_u32 v244, s44, v8
    v_add_u32 v245, s44, v9
    v_add_u32 v246, s44, v10
    v_add_u32 v247, s44, v11
    s_cmp_ge_u32 s48, s46
    s_cbranch_scc1 Lw_9
Lw_10:
    ds_read_b32 v12, v3 offset:4816
    s_waitcnt lgkmcnt(0)
    v_readfirstlane_b32 s48, v12
    s_cmp_ge_u32 s48, s46
    s_cbranch_scc1 Lw_9
    s_sleep 1
    s_sub_u32 s64, s64, 1
    s_cbranch_scc0 Lw_10
    s_mov_b32 s64, 0
Lw_9:
    ds_read_b128 v[80:83], v244 offset:0
    ds_read_b128 v[84:87], v245 offset:0
    ds_read_b128 v[88:91], v246 offset:0
    ds_read_b128 v[92:95], v247 offset:0
    ds_read_b128 v[96:99], v244 offset:256
    ds_read_b128 v[100:103], v245 offset:256
    ds_read_b128 v[104:107], v246 offset:256
    ds_read_b128 v[108:111], v247 offset:256
    ds_read_b128 v[112:115], v244 offset:8192
    ds_read_b128 v[116:119], v245 offset:8192
    ds_read_b128 v[120:123], v246 offset:8192
    ds_read_b128 v[124:127], v247 offset:8192
    ds_read_b128 v[128:131], v244 offset:8448
    ds_read_b128 v[132:135], v245 offset:8448
    ds_read_b128 v[136:139], v246 offset:8448
    ds_read_b128 v[140:143], v247 offset:8448
    s_add_u32 s56, s46, 5
    s_min_u32 s56, s56, 22
    v_mov_b32 v12, s56
    s_add_u32 s46, s46, 6
    s_add_u32 s44, s44, 98304
    s_and_b32 s44, s44, 131071
    s_waitcnt lgkmcnt(0)
    ds_write_b32 v13, v12 offset:4848
    v_add_u32 v244, s44, v8
    v_add_u32 v245, s44, v9
    v_add_u32 v246, s44, v10
    v_add_u32 v247, s44, v11
    s_cmp_ge_u32 s48, s46
    s_cbranch_scc1 Lw_11
Lw_12:
    ds_read_b32 v12, v3 offset:4816
    s_waitcnt lgkmcnt(0)
    v_readfirstlane_b32 s48, v12
    s_cmp_ge_u32 s48, s46
    s_cbranch_scc1 Lw_11
    s_sleep 1
    s_sub_u32 s64, s64, 1
    s_cbranch_scc0 Lw_12
    s_mov_b32 s64, 0
Lw_11:
    ds_read_b128 v[144:147], v244 offset:0
    ds_read_b128 v[148:151], v245 offset:0
    ds_read_b128 v[152:155], v246 offset:0
    ds_read_b128 v[156:159], v247 offset:0
    ds_read_b128 v[160:163], v244 offset:256
    ds_read_b128 v[164:167], v245 offset:256
    ds_read_b128 v[168:171], v246 offset:256
    ds_read_b128 v[172:175], v247 offset:256
    ds_read_b128 v[176:179], v244 offset:8192
    ds_read_b128 v[180:183], v245 offset:8192
    ds_read_b128 v[184:187], v246 offset:8192
    ds_read_b128 v[188:191], v247 offset:8192
    ds_read_b128 v[192:195], v244 offset:8448
    ds_read_b128 v[196:199], v245 offset:8448
    ds_read_b128 v[200:203], v246 offset:8448
    ds_read_b128 v[204:207], v247 offset:8448
    s_add_u32 s56, s46, 5
    s_min_u32 s56, s56, 22
    v_mov_b32 v12, s56
    s_add_u32 s46, s46, 6
    s_add_u32 s44, s44, 98304
    s_and_b32 s44, s44, 131071
    s_waitcnt lgkmcnt(0)
    ds_write_b32 v13, v12 offset:4848
Lw_14:
    ds_read_b32 v12, v3 offset:4820
    s_waitcnt lgkmcnt(0)
    v_readfirstlane_b32 s67, v12
    s_cmp_ge_u32 s67, 1
    s_cbranch_scc1 Lw_13
    s_sleep 1
    s_sub_u32 s64, s64, 1
    s_cbranch_scc0 Lw_14
    s_mov_b32 s64, 0
Lw_13:
    v_and_b32 v12, 1, v2
    v_lshlrev_b32 v12, 9, v12
    v_lshl_add_u32 v12, v1, 4, v12
    v_add_u32 v12, v3, v12
    ds_read_b128 v[208:211], v12 offset:0
    ds_read_b128 v[212:215], v12 offset:64
    ds_read_b128 v[216:219], v12 offset:128
    ds_read_b128 v[220:223], v12 offset:192
    ds_read_b128 v[224:227], v12 offset:256
    ds_read_b128 v[228:231], v12 offset:320
    ds_read_b128 v[232:235], v12 offset:384
    ds_read_b128 v[236:239], v12 offset:448
    s_waitcnt lgkmcnt(0)
    v_mfma_f32_16x16x32_bf16 v[240:243], v[16:19], v[208:211], 0
    v_mfma_f32_16x16x32_bf16 v[244:247], v[48:51], v[208:211], 0
    v_mfma_f32_16x16x32_bf16 v[240:243], v[20:23], v[212:215], v[240:243]
    v_mfma_f32_16x16x32_bf16 v[244:247], v[52:55], v[212:215], v[244:247]
    v_mfma_f32_16x16x32_bf16 v[240:243], v[24:27], v[216:219], v[240:243]
    v_mfma_f32_16x16x32_bf16 v[244:247], v[56:59], v[216:219], v[244:247]
    v_mfma_f32_16x16x32_bf16 v[240:243], v[28:31], v[220:223], v[240:243]
    v_mfma_f32_16x16x32_bf16 v[244:247], v[60:63], v[220:223], v[244:247]
    v_mfma_f32_16x16x32_bf16 v[240:243], v[32:35], v[224:227], v[240:243]
    v_mfma_f32_16x16x32_bf16 v[244:247], v[64:67], v[224:227], v[244:247]
    v_mfma_f32_16x16x32_bf16 v[240:243], v[36:39], v[228:231], v[240:243]
    v_mfma_f32_16x16x32_bf16 v[244:247], v[68:71], v[228:231], v[244:247]
    v_mfma_f32_16x16x32_bf16 v[240:243], v[40:43], v[232:235], v[240:243]
    v_mfma_f32_16x16x32_bf16 v[244:247], v[72:75], v[232:235], v[244:247]
    v_mfma_f32_16x16x32_bf16 v[240:243], v[44:47], v[236:239], v[240:243]
    v_mfma_f32_16x16x32_bf16 v[244:247], v[76:79], v[236:239], v[244:247]
    s_mov_b32 s56, 0x00030003
    s_mov_b32 s57, s56
    s_nop 4
    v_cndmask_b32 v248, v248, v240, s[56:57]
    v_cndmask_b32 v249, v249, v241, s[56:57]
    v_cndmask_b32 v250, v250, v242, s[56:57]
    v_cndmask_b32 v251, v251, v243, s[56:57]
    s_lshl_b64 s[56:57], s[56:57], 2
    v_cndmask_b32 v248, v248, v244, s[56:57]
    v_cndmask_b32 v249, v249, v245, s[56:57]
    v_cndmask_b32 v250, v250, v246, s[56:57]
    v_cndmask_b32 v251, v251, v247, s[56:57]
    v_mfma_f32_16x16x32_bf16 v[240:243], v[80:83], v[208:211], 0
    v_mfma_f32_16x16x32_bf16 v[244:247], v[112:115], v[208:211], 0
    v_mfma_f32_16x16x32_bf16 v[240:243], v[84:87], v[212:215], v[240:243]
    v_mfma_f32_16x16x32_bf16 v[244:247], v[116:119], v[212:215], v[244:247]
    v_mfma_f32_16x16x32_bf16 v[240:243], v[88:91], v[216:219], v[240:243]
    v_mfma_f32_16x16x32_bf16 v[244:247], v[120:123], v[216:219], v[244:247]
    v_mfma_f32_16x16x32_bf16 v[240:243], v[92:95], v[220:223], v[240:243]
    v_mfma_f32_16x16x32_bf16 v[244:247], v[124:127], v[220:223], v[244:247]
    v_mfma_f32_16x16x32_bf16 v[240:243], v[96:99], v[224:227], v[240:243]
    v_mfma_f32_16x16x32_bf16 v[244:247], v[128:131], v[224:227], v[244:247]
    v_mfma_f32_16x16x32_bf16 v[240:243], v[100:103], v[228:231], v[240:243]
    v_mfma_f32_16x16x32_bf16 v[244:247], v[132:135], v[228:231], v[244:247]
    v_mfma_f32_16x16x32_bf16 v[240:243], v[104:107], v[232:235], v[240:243]
    v_mfma_f32_16x16x32_bf16 v[244:247], v[136:139], v[232:235], v[244:247]
    v_mfma_f32_16x16x32_bf16 v[240:243], v[108:111], v[236:239], v[240:243]
    v_mfma_f32_16x16x32_bf16 v[244:247], v[140:143], v[236:239], v[244:247]
    s_mov_b32 s56, 0x00300030
    s_mov_b32 s57, s56
    s_nop 4
    v_cndmask_b32 v248, v248, v240, s[56:57]
    v_cndmask_b32 v249, v249, v241, s[56:57]
    v_cndmask_b32 v250, v250, v242, s[56:57]
    v_cndmask_b32 v251, v251, v243, s[56:57]
    s_lshl_b64 s[56:57], s[56:57], 2
    v_cndmask_b32 v248, v248, v244, s[56:57]
    v_cndmask_b32 v249, v249, v245, s[56:57]
    v_cndmask_b32 v250, v250, v246, s[56:57]
    v_cndmask_b32 v251, v251, v247, s[56:57]
    v_mfma_f32_16x16x32_bf16 v[240:243], v[144:147], v[208:211], 0
    v_mfma_f32_16x16x32_bf16 v[244:247], v[176:179], v[208:211], 0
    v_mfma_f32_16x16x32_bf16 v[240:243], v[148:151], v[212:215], v[240:243]
    v_mfma_f32_16x16x32_bf16 v[244:247], v[180:183], v[212:215], v[244:247]
    v_mfma_f32_16x16x32_bf16 v[240:243], v[152:155], v[216:219], v[240:243]
    v_mfma_f32_16x16x32_bf16 v[244:247], v[184:187], v[216:219], v[244:247]
    v_mfma_f32_16x16x32_bf16 v[240:243], v[156:159], v[220:223], v[240:243]
    v_mfma_f32_16x16x32_bf16 v[244:247], v[188:191], v[220:223], v[244:247]
    v_mfma_f32_16x16x32_bf16 v[240:243], v[160:163], v[224:227], v[240:243]
    v_mfma_f32_16x16x32_bf16 v[244:247], v[192:195], v[224:227], v[244:247]
    v_mfma_f32_16x16x32_bf16 v[240:243], v[164:167], v[228:231], v[240:243]
    v_mfma_f32_16x16x32_bf16 v[244:247], v[196:199], v[228:231], v[244:247]
    v_mfma_f32_16x16x32_bf16 v[240:243], v[168:171], v[232:235], v[240:243]
    v_mfma_f32_16x16x32_bf16 v[244:247], v[200:203], v[232:235], v[244:247]
    v_mfma_f32_16x16x32_bf16 v[240:243], v[172:175], v[236:239], v[240:243]
    v_mfma_f32_16x16x32_bf16 v[244:247], v[204:207], v[236:239], v[244:247]
    s_mov_b32 s56, 0x03000300
    s_mov_b32 s57, s56
    s_nop 4
    v_cndmask_b32 v248, v248, v240, s[56:57]
    v_cndmask_b32 v249, v249, v241, s[56:57]
    v_cndmask_b32 v250, v250, v242, s[56:57]
    v_cndmask_b32 v251, v251, v243, s[56:57]
    s_lshl_b64 s[56:57], s[56:57], 2
    v_cndmask_b32 v248, v248, v244, s[56:57]
    v_cndmask_b32 v249, v249, v245, s[56:57]
    v_cndmask_b32 v250, v250, v246, s[56:57]
    v_cndmask_b32 v251, v251, v247, s[56:57]
    s_cmp_gt_u32 s46, 22
    s_cbranch_scc1 L_kdone
    v_add_u32 v244, s44, v8
    v_add_u32 v245, s44, v9
    v_add_u32 v246, s44, v10
    v_add_u32 v247, s44, v11
    s_cmp_ge_u32 s48, s46
    s_cbranch_scc1 Lw_15
Lw_16:
    ds_read_b32 v12, v3 offset:4816
    s_waitcnt lgkmcnt(0)
    v_readfirstlane_b32 s48, v12
    s_cmp_ge_u32 s48, s46
    s_cbranch_scc1 Lw_15
    s_sleep 1
    s_sub_u32 s64, s64, 1
    s_cbranch_scc0 Lw_16
    s_mov_b32 s64, 0
Lw_15:
    ds_read_b128 v[16:19], v244 offset:0
    ds_read_b128 v[20:23], v245 offset:0
    ds_read_b128 v[24:27], v246 offset:0
    ds_read_b128 v[28:31], v247 offset:0
    ds_read_b128 v[32:35], v244 offset:256
    ds_read_b128 v[36:39], v245 offset:256
    ds_read_b128 v[40:43], v246 offset:256
    ds_read_b128 v[44:47], v247 offset:256
    ds_read_b128 v[48:51], v244 offset:8192
    ds_read_b128 v[52:55], v245 offset:8192
    ds_read_b128 v[56:59], v246 offset:8192
    ds_read_b128 v[60:63], v247 offset:8192
    ds_read_b128 v[64:67], v244 offset:8448
    ds_read_b128 v[68:71], v245 offset:8448
    ds_read_b128 v[72:75], v246 offset:8448
    ds_read_b128 v[76:79], v247 offset:8448
    s_add_u32 s56, s46, 5
    s_min_u32 s56, s56, 22
    v_mov_b32 v12, s56
    s_add_u32 s46, s46, 6
    s_add_u32 s44, s44, 98304
    s_and_b32 s44, s44, 131071
    s_waitcnt lgkmcnt(0)
    ds_write_b32 v13, v12 offset:4848
    v_mfma_f32_16x16x32_bf16 v[240:243], v[16:19], v[208:211], 0
    v_mfma_f32_16x16x32_bf16 v[244:247], v[48:51], v[208:211], 0
    v_mfma_f32_16x16x32_bf16 v[240:243], v[20:23], v[212:215], v[240:243]
    v_mfma_f32_16x16x32_bf16 v[244:247], v[52:55], v[212:215], v[244:247]
    v_mfma_f32_16x16x32_bf16 v[240:243], v[24:27], v[216:219], v[240:243]
    v_mfma_f32_16x16x32_bf16 v[244:247], v[56:59], v[216:219], v[244:247]
    v_mfma_f32_16x16x32_bf16 v[240:243], v[28:31], v[220:223], v[240:243]
    v_mfma_f32_16x16x32_bf16 v[244:247], v[60:63], v[220:223], v[244:247]
    v_mfma_f32_16x16x32_bf16 v[240:243], v[32:35], v[224:227], v[240:243]
    v_mfma_f32_16x16x32_bf16 v[244:247], v[64:67], v[224:227], v[244:247]
    v_mfma_f32_16x16x32_bf16 v[240:243], v[36:39], v[228:231], v[240:243]
    v_mfma_f32_16x16x32_bf16 v[244:247], v[68:71], v[228:231], v[244:247]
    v_mfma_f32_16x16x32_bf16 v[240:243], v[40:43], v[232:235], v[240:243]
    v_mfma_f32_16x16x32_bf16 v[244:247], v[72:75], v[232:235], v[244:247]
    v_mfma_f32_16x16x32_bf16 v[240:243], v[44:47], v[236:239], v[240:243]
    v_mfma_f32_16x16x32_bf16 v[244:247], v[76:79], v[236:239], v[244:247]
    s_mov_b32 s56, 0x30003000
    s_mov_b32 s57, s56
    s_nop 4
    v_cndmask_b32 v248, v248, v240, s[56:57]
    v_cndmask_b32 v249, v249, v241, s[56:57]
    v_cndmask_b32 v250, v250, v242, s[56:57]
    v_cndmask_b32 v251, v251, v243, s[56:57]
    s_lshl_b64 s[56:57], s[56:57], 2
    v_cndmask_b32 v248, v248, v244, s[56:57]
    v_cndmask_b32 v249, v249, v245, s[56:57]
    v_cndmask_b32 v250, v250, v246, s[56:57]
    v_cndmask_b32 v251, v251, v247, s[56:57]
L_kdone:
    v_lshrrev_b32 v23, 2, v2
    v_mul_u32_u24 v16, 192, v23
    v_and_b32 v22, 2, v2
    v_lshl_add_u32 v16, v22, 3, v16
    v_lshl_add_u32 v16, v1, 2, v16
    s_sub_u32 s44, s66, s65
    s_lshl_b32 s45, s61, 5
    s_sub_u32 s44, s44, s45
    v_mov_b32 v17, 0xff800000
    v_cmp_gt_u32 vcc, s44, v16
    v_add_u32 v16, 1, v16
    s_nop 0
    v_cndmask_b32 v248, v17, v248, vcc
    v_cmp_gt_u32 vcc, s44, v16
    v_add_u32 v16, 1, v16
    s_nop 0
    v_cndmask_b32 v249, v17, v249, vcc
    v_cmp_gt_u32 vcc, s44, v16
    v_add_u32 v16, 1, v16
    s_nop 0
    v_cndmask_b32 v250, v17, v250, vcc
    v_cmp_gt_u32 vcc, s44, v16
    v_add_u32 v16, 1, v16
    s_nop 0
    v_cndmask_b32 v251, v17, v251, vcc
    v_cvt_pk_bf16_f32 v16, v248, v249
    v_cvt_pk_bf16_f32 v17, v250, v251
    v_lshlrev_b32 v248, 16, v16
    v_and_b32 v249, 0xffff0000, v16
    v_lshlrev_b32 v250, 16, v17
    v_and_b32 v251, 0xffff0000, v17
    v_max3_f32 v16, v248, v249, v250
    v_max_f32 v16, v16, v251
    s_nop 1
    v_max_f32_dpp v16, v16, v16 row_ror:2 row_mask:0xf bank_mask:0xf
    s_nop 1
    v_max_f32_dpp v16, v16, v16 row_ror:4 row_mask:0xf bank_mask:0xf
    s_nop 1
    v_max_f32_dpp v16, v16, v16 row_ror:8 row_mask:0xf bank_mask:0xf
    v_and_b32 v17, 1, v2
    v_lshl_add_u32 v18, v17, 2, v3
    s_mov_b32 s56, 0x00030003
    s_mov_b32 s57, s56
    s_mov_b64 exec, s[56:57]
    ds_max_f32 v18, v16 offset:4736
    s_mov_b64 exec, 1
    v_mov_b32 v12, 1
    ds_add_u32 v3, v12 offset:4824
    s_mov_b64 exec, -1
    v_mul_u32_u24 v19, 384, v23
    v_mul_u32_u24 v14, 1536, v17
    v_lshl_add_u32 v14, v1, 4, v14
    v_add_u32 v14, v3, v14
    v_lshl_add_u32 v19, v22, 2, v19
    s_lshl_b32 s62, s61, 6
    v_add3_u32 v19, v19, s62, v14
    v_lshlrev_b32 v20, 7, v17
    v_lshl_add_u32 v20, v1, 2, v20
    s_lshl_b32 s62, s61, 4
    v_add3_u32 v20, v20, s62, v3
Lw_18:
    ds_read_b32 v12, v3 offset:4824
    s_waitcnt lgkmcnt(0)
    v_readfirstlane_b32 s47, v12
    s_cmp_ge_u32 s47, 6
    s_cbranch_scc1 Lw_17
    s_sub_u32 s64, s64, 1
    s_cbranch_scc0 Lw_18
    s_mov_b32 s64, 0
Lw_17:
    ds_read_b32 v16, v18 offset:4736
    s_waitcnt lgkmcnt(0)
    v_sub_f32 v248, v248, v16
    v_mul_f32 v248, 0x3db8aa3b, v248
    v_exp_f32 v248, v248
    v_sub_f32 v249, v249, v16
    v_mul_f32 v249, 0x3db8aa3b, v249
    v_exp_f32 v249, v249
    v_sub_f32 v250, v250, v16
    v_mul_f32 v250, 0x3db8aa3b, v250
    v_exp_f32 v250, v250
    v_sub_f32 v251, v251, v16
    v_mul_f32 v251, 0x3db8aa3b, v251
    v_exp_f32 v251, v251
    v_add_f32 v16, v248, v249
    v_add_f32 v16, v16, v250
    v_add_f32 v16, v16, v251
    v_cvt_pk_bf16_f32 v24, v248, v249
    v_cvt_pk_bf16_f32 v25, v250, v251
    ds_write_b64 v19, v[24:25] offset:1024
    v_add_f32_dpp v16, v16, v16 row_ror:2 row_mask:0xf bank_mask:0xf
    s_nop 1
    v_add_f32_dpp v16, v16, v16 row_ror:4 row_mask:0xf bank_mask:0xf
    s_nop 1
    v_add_f32_dpp v16, v16, v16 row_ror:8 row_mask:0xf bank_mask:0xf
    s_nop 1
    s_mov_b64 exec, s[56:57]
    ds_write_b32 v20, v16 offset:4096
    s_mov_b64 exec, 1
    v_mov_b32 v12, 1
    ds_add_u32 v3, v12 offset:4828
    s_mov_b64 exec, -1
    s_cmp_ge_u32 s3, 4
    s_cbranch_scc1 L_pv
    v_mov_b32 v12, 0x7fff
    ds_write_b32 v13, v12 offset:4848
    s_endpgm
L_pv:
    s_sub_u32 s61, s3, 4
    v_lshrrev_b32 v16, 2, v0
    v_and_b32 v18, 7, v16
    s_lshl_b32 s62, s61, 2
    v_xor_b32 v18, s62, v18
    v_lshlrev_b32 v18, 5, v18
    v_lshl_or_b32 v18, v16, 9, v18
    v_and_b32 v16, 3, v0
    v_lshl_or_b32 v8, v16, 3, v18
    v_xor_b32 v9, 32, v8
    v_xor_b32 v10, 64, v8
    v_xor_b32 v11, 96, v8
    v_mov_b32 v96, 0
    v_mov_b32 v97, 0
    v_mov_b32 v98, 0
    v_mov_b32 v99, 0
    v_mov_b32 v40, 0
    v_mov_b32 v41, 0
    v_mov_b32 v42, 0
    v_mov_b32 v43, 0
    v_mov_b32 v44, 0
    v_mov_b32 v45, 0
    v_mov_b32 v46, 0
    v_mov_b32 v47, 0
    v_mov_b32 v48, 0
    v_mov_b32 v49, 0
    v_mov_b32 v50, 0
    v_mov_b32 v51, 0
    v_mov_b32 v52, 0
    v_mov_b32 v53, 0
    v_mov_b32 v54, 0
    v_mov_b32 v55, 0
    v_lshlrev_b32 v112, 7, v1
    v_lshl_add_u32 v112, v2, 4, v112
    s_lshl_b32 s40, s32, 15
    s_lshl_b32 s56, s61, 9
    s_add_u32 s40, s40, s56
    s_lshl_b32 s56, s33, 11
    s_add_u32 s40, s40, s56
    s_add_u32 s40, s40, 131072
    s_mov_b32 s4, 0x00030003
    s_mov_b32 s5, s4
    s_mov_b32 s6, 0x000c000c
    s_mov_b32 s7, s6
    s_mov_b32 s8, 0x00300030
    s_mov_b32 s9, s8
    s_mov_b32 s10, 0x00c000c0
    s_mov_b32 s11, s10
    s_mov_b32 s12, 0x00ff00ff
    s_mov_b32 s13, s12
Lw_20:
    ds_read_b32 v12, v3 offset:4828
    s_waitcnt lgkmcnt(0)
    v_readfirstlane_b32 s47, v12
    s_cmp_ge_u32 s47, 6
    s_cbranch_scc1 Lw_19
    s_sub_u32 s64, s64, 1
    s_cbranch_scc0 Lw_20
    s_mov_b32 s64, 0
Lw_19:
    s_mov_b32 s46, 23
    s_mov_b32 s44, 98304
L_vloop:
    s_mov_b64 exec, s[4:5]
    ds_read_b128 v[40:43], v14 offset:1024
    s_mov_b64 exec, s[6:7]
    ds_read_b128 v[44:47], v14 offset:1024
    s_mov_b64 exec, s[8:9]
    ds_read_b128 v[48:51], v14 offset:1024
    s_mov_b64 exec, s[10:11]
    ds_read_b128 v[52:55], v14 offset:1024
    s_mov_b64 exec, -1
    v_add_u32 v16, s44, v8
    v_add_u32 v17, s44, v9
    v_add_u32 v18, s44, v10
    v_add_u32 v19, s44, v11
    s_cmp_lg_u32 s46, 43
    s_cbranch_scc1 L_vw
    s_barrier
    s_branch L_vg
L_vw:
    s_cmp_ge_u32 s48, s46
    s_cbranch_scc1 Lw_21
Lw_22:
    ds_read_b32 v12, v3 offset:4816
    s_waitcnt lgkmcnt(0)
    v_readfirstlane_b32 s48, v12
    s_cmp_ge_u32 s48, s46
    s_cbranch_scc1 Lw_21
    s_sub_u32 s64, s64, 1
    s_cbranch_scc0 Lw_22
    s_mov_b32 s64, 0
Lw_21:
L_vg:
    ds_read_b64_tr_b16 v[24:25], v16
    ds_read_b64_tr_b16 v[26:27], v16 offset:8192
    ds_read_b64_tr_b16 v[28:29], v17
    ds_read_b64_tr_b16 v[30:31], v17 offset:8192
    ds_read_b64_tr_b16 v[32:33], v18
    ds_read_b64_tr_b16 v[34:35], v18 offset:8192
    ds_read_b64_tr_b16 v[36:37], v19
    ds_read_b64_tr_b16 v[38:39], v19 offset:8192
    v_mov_b32 v12, s46
    v_add_u32 v14, 64, v14
    s_add_u32 s44, s44, 16384
    s_and_b32 s44, s44, 131071
    s_add_u32 s46, s46, 1
    s_cmp_le_u32 s46, 43
    s_waitcnt lgkmcnt(6)
    v_mfma_f32_16x16x32_bf16 v[96:99], v[24:27], v[40:43], v[96:99]
    s_waitcnt lgkmcnt(4)
    v_mfma_f32_16x16x32_bf16 v[96:99], v[28:31], v[44:47], v[96:99]
    s_waitcnt lgkmcnt(2)
    v_mfma_f32_16x16x32_bf16 v[96:99], v[32:35], v[48:51], v[96:99]
    s_waitcnt lgkmcnt(0)
    v_mfma_f32_16x16x32_bf16 v[96:99], v[36:39], v[52:55], v[96:99]
    ds_write_b32 v13, v12 offset:4848
    s_cbranch_scc1 L_vloop
    s_mov_b64 exec, s[4:5]
    ds_read_b64 v[40:41], v14 offset:1024
    s_mov_b64 exec, s[6:7]
    ds_read_b64 v[44:45], v14 offset:1024
    s_mov_b64 exec, s[8:9]
    ds_read_b64 v[48:49], v14 offset:1024
    s_mov_b64 exec, s[10:11]
    ds_read_b64 v[52:53], v14 offset:1024
    s_mov_b64 exec, -1
    v_add_u32 v16, s44, v8
    v_add_u32 v17, s44, v9
    v_add_u32 v18, s44, v10
    v_add_u32 v19, s44, v11
    s_cmp_eq_u32 s67, 2
    s_barrier
    ds_read_b64_tr_b16 v[24:25], v16
    ds_read_b64_tr_b16 v[28:29], v17
    ds_read_b64_tr_b16 v[32:33], v18
    ds_read_b64_tr_b16 v[36:37], v19
    s_waitcnt lgkmcnt(3)
    v_mfma_f32_16x16x16_bf16 v[96:99], v[24:25], v[40:41], v[96:99]
    s_waitcnt lgkmcnt(2)
    v_mfma_f32_16x16x16_bf16 v[96:99], v[28:29], v[44:45], v[96:99]
    s_waitcnt lgkmcnt(1)
    v_mfma_f32_16x16x16_bf16 v[96:99], v[32:33], v[48:49], v[96:99]
    s_waitcnt lgkmcnt(0)
    v_mfma_f32_16x16x16_bf16 v[96:99], v[36:37], v[52:53], v[96:99]
    s_mov_b64 exec, s[12:13]
    s_nop 6
    v_and_or_b32 v96, v96, s59, v4
    v_and_or_b32 v97, v97, s59, v5
    v_and_or_b32 v98, v98, s59, v6
    v_and_or_b32 v99, v99, s59, v7
    s_cbranch_scc0 L_slowpub
    buffer_store_dwordx4 v[96:99], v112, s[52:55], s40 offen
    s_branch L_pubdone
L_slowpub:
    buffer_store_dwordx4 v[96:99], v112, s[52:55], s40 offen sc1
L_pubdone:
    s_endpgm
L_service:
    v_mov_b32 v3, 151552
    v_lshrrev_b32 v1, 4, v0
    v_and_b32 v2, 15, v0
    s_waitcnt lgkmcnt(0)
    s_load_dwordx4 s[28:31], s[26:27], 0
    s_mov_b32 s52, s26
    s_mov_b32 s53, s27
    s_mov_b32 s54, 1048576
    s_mov_b32 s55, 0x20000
    s_mov_b32 s58, 1023
    s_mov_b32 s59, 4294966272
    s_sub_u32 s33, s2, 192
    s_lshr_b32 s33, s33, 3
    s_mov_b32 s40, s4
    s_mov_b32 s41, s5
    s_mov_b32 s42, 1792
    s_mov_b32 s43, 0x20000
    s_cmp_lg_u32 s3, 0
    s_cbranch_scc1 L_s1
    v_lshrrev_b32 v8, 5, v0
    v_and_b32 v9, 31, v0
    v_mul_u32_u24 v10, 896, v8
    v_lshl_add_u32 v10, v9, 4, v10
    v_cmp_gt_u32 vcc, 28, v9
    v_mov_b32 v11, 0x1000
    s_nop 0
    v_cndmask_b32 v11, v11, v10, vcc
    buffer_load_dwordx4 v[16:19], v11, s[40:43], 0 offen
    buffer_load_dwordx4 v[20:23], v11, s[40:43], 0 offen offset:448
L_s1:
    v_lshrrev_b32 v12, 3, v0
    v_and_b32 v13, 7, v0
    v_lshlrev_b32 v13, 4, v13
    v_lshl_add_u32 v14, v12, 13, v13
    v_mul_u32_u24 v15, 896, v12
    v_add_u32 v15, v15, v13
    s_mov_b32 s36, s10
    s_mov_b32 s37, s11
    s_mov_b32 s38, 3670016
    s_mov_b32 s39, 0x20000
    v_min_u32 v12, 6, v12
    v_lshlrev_b32 v12, 13, v12
    v_lshl_add_u32 v12, v13, 3, v12
    s_mul_i32 s46, s33, 56
    s_mul_i32 s56, s3, 7
    s_add_u32 s46, s46, s56
    s_lshl_b32 s46, s46, 13
    s_lshl_b32 s56, s35, 10
    s_add_u32 s46, s46, s56
    buffer_load_dword v45, v12, s[36:39], s46 offen
    s_lshl_b32 s44, s35, 3
    s_add_u32 s44, s44, s33
    s_lshl_b32 s45, s44, 7
    s_mul_i32 s56, s3, 458752
    s_add_u32 s45, s45, s56
    s_waitcnt lgkmcnt(0)
    s_add_u32 s28, s28, 1
    s_and_b32 s28, s28, 1023
    v_mov_b32 v4, s28
    s_add_u32 s29, s29, 7
    s_and_b32 s29, s29, 1023
    v_mov_b32 v5, s29
    s_add_u32 s30, s30, 19
    s_and_b32 s30, s30, 1023
    v_mov_b32 v6, s30
    s_add_u32 s31, s31, 45
    s_and_b32 s31, s31, 1023
    v_mov_b32 v7, s31
    s_cmp_lg_u32 s3, 1
    s_cbranch_scc1 L_s2
    v_lshl_add_u32 v9, v0, 4, v3
    v_mov_b32 v28, 0
    v_mov_b32 v29, 0
    v_mov_b32 v30, 0
    v_mov_b32 v31, 0
    s_mov_b64 exec, 0xffffffff
    ds_write_b128 v9, v[28:31] offset:4480
    s_mov_b64 exec, -1
L_s2:
    s_cmp_lg_u32 s3, 0
    s_cbranch_scc1 L_s3
    s_waitcnt vmcnt(1)
    v_lshlrev_b32 v24, 16, v16
    v_and_b32 v25, 0xffff0000, v16
    v_lshlrev_b32 v26, 16, v17
    v_and_b32 v27, 0xffff0000, v17
    v_lshlrev_b32 v28, 16, v18
    v_and_b32 v29, 0xffff0000, v18
    v_lshlrev_b32 v30, 16, v19
    v_and_b32 v31, 0xffff0000, v19
    v_lshlrev_b32 v32, 16, v20
    v_and_b32 v33, 0xffff0000, v20
    v_lshlrev_b32 v34, 16, v21
    v_and_b32 v35, 0xffff0000, v21
    v_lshlrev_b32 v36, 16, v22
    v_and_b32 v37, 0xffff0000, v22
    v_lshlrev_b32 v38, 16, v23
    v_and_b32 v39, 0xffff0000, v23
    v_add_f32 v40, v24, v25
    v_mul_f32 v41, v24, v24
    v_fmac_f32 v41, v25, v25
    v_add_f32 v40, v40, v26
    v_fmac_f32 v41, v26, v26
    v_add_f32 v40, v40, v27
    v_fmac_f32 v41, v27, v27
    v_add_f32 v40, v40, v28
    v_fmac_f32 v41, v28, v28
    v_add_f32 v40, v40, v29
    v_fmac_f32 v41, v29, v29
    v_add_f32 v40, v40, v30
    v_fmac_f32 v41, v30, v30
    v_add_f32 v40, v40, v31
    v_fmac_f32 v41, v31, v31
    v_add_f32 v40, v40, v32
    v_fmac_f32 v41, v32, v32
    v_add_f32 v40, v40, v33
    v_fmac_f32 v41, v33, v33
    v_add_f32 v40, v40, v34
    v_fmac_f32 v41, v34, v34
    v_add_f32 v40, v40, v35
    v_fmac_f32 v41, v35, v35
    v_add_f32 v40, v40, v36
    v_fmac_f32 v41, v36, v36
    v_add_f32 v40, v40, v37
    v_fmac_f32 v41, v37, v37
    v_add_f32 v40, v40, v38
    v_fmac_f32 v41, v38, v38
    v_add_f32 v40, v40, v39
    v_fmac_f32 v41, v39, v39
    s_nop 0
    v_add_f32_dpp v40, v40, v40 row_ror:1 row_mask:0xf bank_mask:0xf
    v_add_f32_dpp v41, v41, v41 row_ror:1 row_mask:0xf bank_mask:0xf
    s_nop 0
    v_add_f32_dpp v40, v40, v40 row_ror:2 row_mask:0xf bank_mask:0xf
    v_add_f32_dpp v41, v41, v41 row_ror:2 row_mask:0xf bank_mask:0xf
    s_nop 0
    v_add_f32_dpp v40, v40, v40 row_ror:4 row_mask:0xf bank_mask:0xf
    v_add_f32_dpp v41, v41, v41 row_ror:4 row_mask:0xf bank_mask:0xf
    s_nop 0
    v_add_f32_dpp v40, v40, v40 row_ror:8 row_mask:0xf bank_mask:0xf
    v_add_f32_dpp v41, v41, v41 row_ror:8 row_mask:0xf bank_mask:0xf
    v_mov_b32 v42, v40
    v_mov_b32 v43, v41
    s_nop 1
    v_permlane16_swap_b32 v40, v42
    v_permlane16_swap_b32 v41, v43
    v_add_f32 v40, v40, v42
    v_add_f32 v41, v41, v43
    v_mul_f32 v40, 0x3b124925, v40
    v_mul_f32 v41, 0x3b124925, v41
    v_fma_f32 v41, -v40, v40, v41
    v_max_f32 v41, 0, v41
    v_cvt_pk_bf16_f32 v44, v40, v41
    v_and_b32 v41, 0xffff0000, v44
    v_lshlrev_b32 v42, 16, v44
    v_add_f32 v41, 0x3727c5ac, v41
    v_cvt_pk_bf16_f32 v44, v41, v41
    v_lshlrev_b32 v41, 16, v44
    v_sqrt_f32 v41, v41
    s_nop 0
    v_cvt_pk_bf16_f32 v44, v41, v41
    v_lshlrev_b32 v41, 16, v44
    v_rcp_f32 v43, v41
    s_nop 0
    v_sub_f32 v24, v24, v42
    v_sub_f32 v25, v25, v42
    v_cvt_pk_bf16_f32 v44, v24, v25
    v_lshlrev_b32 v24, 16, v44
    v_and_b32 v25, 0xffff0000, v44
    v_mul_f32 v24, v24, v43
    v_mul_f32 v25, v25, v43
    v_cvt_pk_bf16_f32 v16, v24, v25
    v_sub_f32 v26, v26, v42
    v_sub_f32 v27, v27, v42
    v_cvt_pk_bf16_f32 v44, v26, v27
    v_lshlrev_b32 v26, 16, v44
    v_and_b32 v27, 0xffff0000, v44
    v_mul_f32 v26, v26, v43
    v_mul_f32 v27, v27, v43
    v_cvt_pk_bf16_f32 v17, v26, v27
    v_sub_f32 v28, v28, v42
    v_sub_f32 v29, v29, v42
    v_cvt_pk_bf16_f32 v44, v28, v29
    v_lshlrev_b32 v28, 16, v44
    v_and_b32 v29, 0xffff0000, v44
    v_mul_f32 v28, v28, v43
    v_mul_f32 v29, v29, v43
    v_cvt_pk_bf16_f32 v18, v28, v29
    v_sub_f32 v30, v30, v42
    v_sub_f32 v31, v31, v42
    v_cvt_pk_bf16_f32 v44, v30, v31
    v_lshlrev_b32 v30, 16, v44
    v_and_b32 v31, 0xffff0000, v44
    v_mul_f32 v30, v30, v43
    v_mul_f32 v31, v31, v43
    v_cvt_pk_bf16_f32 v19, v30, v31
    v_sub_f32 v32, v32, v42
    v_sub_f32 v33, v33, v42
    v_cvt_pk_bf16_f32 v44, v32, v33
    v_lshlrev_b32 v32, 16, v44
    v_and_b32 v33, 0xffff0000, v44
    v_mul_f32 v32, v32, v43
    v_mul_f32 v33, v33, v43
    v_cvt_pk_bf16_f32 v20, v32, v33
    v_sub_f32 v34, v34, v42
    v_sub_f32 v35, v35, v42
    v_cvt_pk_bf16_f32 v44, v34, v35
    v_lshlrev_b32 v34, 16, v44
    v_and_b32 v35, 0xffff0000, v44
    v_mul_f32 v34, v34, v43
    v_mul_f32 v35, v35, v43
    v_cvt_pk_bf16_f32 v21, v34, v35
    v_sub_f32 v36, v36, v42
    v_sub_f32 v37, v37, v42
    v_cvt_pk_bf16_f32 v44, v36, v37
    v_lshlrev_b32 v36, 16, v44
    v_and_b32 v37, 0xffff0000, v44
    v_mul_f32 v36, v36, v43
    v_mul_f32 v37, v37, v43
    v_cvt_pk_bf16_f32 v22, v36, v37
    v_sub_f32 v38, v38, v42
    v_sub_f32 v39, v39, v42
    v_cvt_pk_bf16_f32 v44, v38, v39
    v_lshlrev_b32 v38, 16, v44
    v_and_b32 v39, 0xffff0000, v44
    v_mul_f32 v38, v38, v43
    v_mul_f32 v39, v39, v43
    v_cvt_pk_bf16_f32 v23, v38, v39
    v_add_u32 v10, v3, v10
    s_mov_b32 s56, 0x0fffffff
    s_mov_b32 s57, s56
    s_mov_b64 exec, s[56:57]
    ds_write_b128 v10, v[16:19] offset:0
    ds_write_b128 v10, v[20:23] offset:448
    s_mov_b64 exec, -1
L_s3:
    s_waitcnt vmcnt(0)
    s_barrier
    s_mul_i32 s56, s3, 7168
    s_add_u32 m0, s56, 0
    s_nop 0
    buffer_load_dwordx4 v14, s[36:39], s45 offen nt lds
    s_add_u32 m0, m0, 1024
    s_add_u32 s45, s45, 65536
    buffer_load_dwordx4 v14, s[36:39], s45 offen nt lds
    s_add_u32 m0, m0, 1024
    s_add_u32 s45, s45, 65536
    buffer_load_dwordx4 v14, s[36:39], s45 offen nt lds
    s_add_u32 m0, m0, 1024
    s_add_u32 s45, s45, 65536
    buffer_load_dwordx4 v14, s[36:39], s45 offen nt lds
    s_add_u32 m0, m0, 1024
    s_add_u32 s45, s45, 65536
    buffer_load_dwordx4 v14, s[36:39], s45 offen nt lds
    s_add_u32 m0, m0, 1024
    s_add_u32 s45, s45, 65536
    buffer_load_dwordx4 v14, s[36:39], s45 offen nt lds
    s_add_u32 m0, m0, 1024
    s_add_u32 s45, s45, 65536
    buffer_load_dwordx4 v14, s[36:39], s45 offen nt lds
    v_lshrrev_b32 v9, 2, v2
    v_lshl_add_u32 v9, v1, 3, v9
    v_lshlrev_b32 v11, 7, v9
    v_and_b32 v10, 3, v0
    s_waitcnt vmcnt(0) lgkmcnt(0)
    s_barrier
    s_cmp_ge_u32 s3, 4
    s_cbranch_scc1 L_s4
    v_and_b32 v8, 1, v2
    v_mul_u32_u24 v8, 896, v8
    v_lshl_add_u32 v8, v1, 4, v8
    v_add_u32 v8, v3, v8
    v_lshl_add_u32 v12, v10, 3, v11
    s_lshl_b32 s56, s3, 5
    v_add_u32 v12, s56, v12
    ds_read_b128 v[16:19], v8 offset:0
    ds_read_b64_tr_b16 v[72:73], v12 offset:0
    ds_read_b64_tr_b16 v[74:75], v12 offset:512
    ds_read_b128 v[20:23], v8 offset:64
    ds_read_b64_tr_b16 v[76:77], v12 offset:4096
    ds_read_b64_tr_b16 v[78:79], v12 offset:4608
    ds_read_b128 v[24:27], v8 offset:128
    ds_read_b64_tr_b16 v[80:81], v12 offset:8192
    ds_read_b64_tr_b16 v[82:83], v12 offset:8704
    ds_read_b128 v[28:31], v8 offset:192
    ds_read_b64_tr_b16 v[84:85], v12 offset:12288
    ds_read_b64_tr_b16 v[86:87], v12 offset:12800
    ds_read_b128 v[32:35], v8 offset:256
    ds_read_b64_tr_b16 v[88:89], v12 offset:16384
    ds_read_b64_tr_b16 v[90:91], v12 offset:16896
    ds_read_b128 v[36:39], v8 offset:320
    ds_read_b64_tr_b16 v[92:93], v12 offset:20480
    ds_read_b64_tr_b16 v[94:95], v12 offset:20992
    ds_read_b128 v[40:43], v8 offset:384
    ds_read_b64_tr_b16 v[96:97], v12 offset:24576
    ds_read_b64_tr_b16 v[98:99], v12 offset:25088
    ds_read_b128 v[44:47], v8 offset:448
    ds_read_b64_tr_b16 v[100:101], v12 offset:28672
    ds_read_b64_tr_b16 v[102:103], v12 offset:29184
    ds_read_b128 v[48:51], v8 offset:512
    ds_read_b64_tr_b16 v[104:105], v12 offset:32768
    ds_read_b64_tr_b16 v[106:107], v12 offset:33280
    ds_read_b128 v[52:55], v8 offset:576
    ds_read_b64_tr_b16 v[108:109], v12 offset:36864
    ds_read_b64_tr_b16 v[110:111], v12 offset:37376
    ds_read_b128 v[56:59], v8 offset:640
    ds_read_b64_tr_b16 v[112:113], v12 offset:40960
    ds_read_b64_tr_b16 v[114:115], v12 offset:41472
    ds_read_b128 v[60:63], v8 offset:704
    ds_read_b64_tr_b16 v[116:117], v12 offset:45056
    ds_read_b64_tr_b16 v[118:119], v12 offset:45568
    ds_read_b128 v[64:67], v8 offset:768
    ds_read_b64_tr_b16 v[120:121], v12 offset:49152
    ds_read_b64_tr_b16 v[122:123], v12 offset:49664
    ds_read_b128 v[68:71], v8 offset:832
    ds_read_b64_tr_b16 v[124:125], v12 offset:53248
    ds_read_b64_tr_b16 v[126:127], v12 offset:53760
    s_waitcnt lgkmcnt(0)
    v_mfma_f32_16x16x32_bf16 v[128:131], v[72:75], v[16:19], 0
    v_mfma_f32_16x16x32_bf16 v[128:131], v[76:79], v[20:23], v[128:131]
    v_mfma_f32_16x16x32_bf16 v[128:131], v[80:83], v[24:27], v[128:131]
    v_mfma_f32_16x16x32_bf16 v[128:131], v[84:87], v[28:31], v[128:131]
    v_mfma_f32_16x16x32_bf16 v[128:131], v[88:91], v[32:35], v[128:131]
    v_mfma_f32_16x16x32_bf16 v[128:131], v[92:95], v[36:39], v[128:131]
    v_mfma_f32_16x16x32_bf16 v[128:131], v[96:99], v[40:43], v[128:131]
    v_mfma_f32_16x16x32_bf16 v[128:131], v[100:103], v[44:47], v[128:131]
    v_mfma_f32_16x16x32_bf16 v[128:131], v[104:107], v[48:51], v[128:131]
    v_mfma_f32_16x16x32_bf16 v[128:131], v[108:111], v[52:55], v[128:131]
    v_mfma_f32_16x16x32_bf16 v[128:131], v[112:115], v[56:59], v[128:131]
    v_mfma_f32_16x16x32_bf16 v[128:131], v[116:119], v[60:63], v[128:131]
    v_mfma_f32_16x16x32_bf16 v[128:131], v[120:123], v[64:67], v[128:131]
    v_mfma_f32_16x16x32_bf16 v[128:131], v[124:127], v[68:71], v[128:131]
    v_and_b32 v16, 1, v2
    v_lshlrev_b32 v16, 14, v16
    v_lshl_add_u32 v16, v1, 4, v16
    s_lshl_b32 s45, s44, 8
    s_lshl_b32 s56, s3, 6
    s_add_u32 s45, s45, s56
    s_add_u32 s45, s45, 4096
    s_getreg_b32 s46, hwreg(HW_REG_XCC_ID)
    s_and_b32 s46, s46, 15
    s_lshl_b32 s46, s46, 10
    v_cvt_pk_bf16_f32 v12, v128, v129
    v_cvt_pk_bf16_f32 v13, v130, v131
    v_lshl_or_b32 v128, v12, 16, v4
    v_and_b32 v129, 0xffff0000, v12
    v_or_b32 v129, v129, v5
    v_lshl_or_b32 v130, v13, 16, v6
    v_and_b32 v131, 0xffff0000, v13
    v_or_b32 v131, v131, v7
    v_or_b32 v128, s46, v128
    s_mov_b32 s56, 0x00030003
    s_mov_b32 s57, s56
    s_mov_b64 exec, s[56:57]
    buffer_store_dwordx4 v[128:131], v16, s[52:55], s45 offen sc1
    s_mov_b64 exec, -1
L_s4:
    s_cmp_lt_u32 s33, 7
    s_cbranch_scc1 L_s5
    s_lshr_b32 s56, s3, 2
    s_lshl_b32 s47, s56, 3
    s_add_u32 s47, s47, s35
    s_lshl_b32 s47, s47, 15
    s_and_b32 s56, s3, 3
    s_mul_i32 s56, s56, 6144
    s_add_u32 s47, s47, s56
    s_add_u32 s47, s47, 131072
    v_min_u32 v8, 47, v0
    v_lshlrev_b32 v8, 7, v8
    buffer_load_dword v9, v8, s[52:55], s47 offen sc1
    s_endpgm
L_s5:
    s_mul_i32 s65, s35, 7
    s_add_u32 s65, s65, s33
    s_cmp_lt_u32 s3, 4
    s_cselect_b32 s36, s16, s18
    s_cselect_b32 s37, s17, s19
    s_mov_b32 s38, 1605632
    v_lshrrev_b32 v14, 2, v0
    v_mul_u32_u24 v14, 3584, v14
    v_lshl_add_u32 v12, v10, 7, v14
    v_lshl_add_u32 v14, v10, 4, v14
    s_lshl_b32 s46, s33, 2
    s_and_b32 s57, s3, 3
    s_add_u32 s46, s46, s57
    s_mul_i32 s46, s46, 57344
    s_mul_i32 s56, s35, 448
    s_and_b32 s56, s56, 0xffffff80
    s_add_u32 s46, s46, s56
    buffer_load_dword v45, v12, s[36:39], s46 offen
    s_mov_b32 s60, s12
    s_mov_b32 s61, s13
    s_mov_b32 s62, 3670016
    s_mov_b32 s63, 0x20000
    v_lshlrev_b32 v12, 7, v0
    s_lshl_b32 s46, s65, 16
    s_lshl_b32 s56, s3, 13
    s_add_u32 s46, s46, s56
    buffer_load_dword v46, v12, s[60:63], s46 offen
    s_mul_i32 s45, s57, 401408
    s_lshl_b32 s56, s65, 6
    s_add_u32 s45, s45, s56
    s_waitcnt vmcnt(1)
    s_barrier
    s_mul_i32 s56, s3, 7168
    s_add_u32 m0, s56, 65536
    s_nop 0
    buffer_load_dwordx4 v14, s[36:39], s45 offen nt lds
    s_add_u32 m0, m0, 1024
    s_add_u32 s45, s45, 57344
    buffer_load_dwordx4 v14, s[36:39], s45 offen nt lds
    s_add_u32 m0, m0, 1024
    s_add_u32 s45, s45, 57344
    buffer_load_dwordx4 v14, s[36:39], s45 offen nt lds
    s_add_u32 m0, m0, 1024
    s_add_u32 s45, s45, 57344
    buffer_load_dwordx4 v14, s[36:39], s45 offen nt lds
    s_add_u32 m0, m0, 1024
    s_add_u32 s45, s45, 57344
    buffer_load_dwordx4 v14, s[36:39], s45 offen nt lds
    s_add_u32 m0, m0, 1024
    s_add_u32 s45, s45, 57344
    buffer_load_dwordx4 v14, s[36:39], s45 offen nt lds
    s_add_u32 m0, m0, 1024
    s_add_u32 s45, s45, 57344
    buffer_load_dwordx4 v14, s[36:39], s45 offen nt lds
    v_lshlrev_b32 v14, 4, v0
    s_mul_i32 s45, s65, 28672
    s_mov_b32 s36, s20
    s_mov_b32 s37, s21
    s_mov_b32 s38, 1605632
    s_lshl_b32 s56, s3, 12
    s_add_u32 s45, s45, s56
    s_add_u32 m0, s56, 122880
    s_cmp_eq_u32 s3, 7
    s_cbranch_scc1 L_s5a
    buffer_load_dwordx4 v14, s[36:39], s45 offen offset:0 nt lds
    buffer_load_dwordx4 v14, s[36:39], s45 offen offset:1024 nt lds
    buffer_load_dwordx4 v14, s[36:39], s45 offen offset:2048 nt lds
    buffer_load_dwordx4 v14, s[36:39], s45 offen offset:3072 nt lds
L_s5a:
    s_mov_b32 s36, s12
    s_mov_b32 s37, s13
    s_mov_b32 s38, 3670016
    s_mul_i32 s45, s35, 458752
    s_mul_i32 s56, s3, 57344
    s_add_u32 s45, s45, s56
    s_lshl_b32 s56, s33, 7
    s_add_u32 s45, s45, s56
    s_mul_i32 s56, s3, 8192
    s_add_u32 m0, s56, 0
    s_nop 0
    buffer_load_dwordx4 v15, s[36:39], s45 offen nt lds
    s_add_u32 m0, m0, 1024
    s_add_u32 s45, s45, 7168
    buffer_load_dwordx4 v15, s[36:39], s45 offen nt lds
    s_add_u32 m0, m0, 1024
    s_add_u32 s45, s45, 7168
    buffer_load_dwordx4 v15, s[36:39], s45 offen nt lds
    s_add_u32 m0, m0, 1024
    s_add_u32 s45, s45, 7168
    buffer_load_dwordx4 v15, s[36:39], s45 offen nt lds
    s_add_u32 m0, m0, 1024
    s_add_u32 s45, s45, 7168
    buffer_load_dwordx4 v15, s[36:39], s45 offen nt lds
    s_add_u32 m0, m0, 1024
    s_add_u32 s45, s45, 7168
    buffer_load_dwordx4 v15, s[36:39], s45 offen nt lds
    s_add_u32 m0, m0, 1024
    s_add_u32 s45, s45, 7168
    buffer_load_dwordx4 v15, s[36:39], s45 offen nt lds
    s_add_u32 m0, m0, 1024
    s_add_u32 s45, s45, 7168
    buffer_load_dwordx4 v15, s[36:39], s45 offen nt lds
    s_getpc_b64 s[56:57]
L_pc:
    s_lshl_b32 s46, s3, 10
    v_add_u32 v14, s46, v14
    v_min_u32 v14, L_end-L_pc-12, v14
    global_load_dwordx4 v[28:31], v14, s[56:57]
    v_lshlrev_b32 v21, 4, v1
    v_add_u32 v22, v21, v3
    s_mov_b32 s48, 0xcccccccc
    s_mov_b32 s49, s48
    s_mov_b32 s50, 0xf0f0f0f0
    s_mov_b32 s51, s50
    v_and_b32 v12, 8, v2
    v_lshlrev_b32 v12, 2, v12
    v_lshl_add_u32 v12, v10, 3, v12
    v_lshl_add_u32 v12, v1, 1, v12
    s_lshl_b32 s56, s3, 7
    v_add_u32 v12, s56, v12
    v_bfe_u32 v13, v2, 2, 1
    v_mul_u32_u24 v248, 960, v13
    v_add3_u32 v248, v248, v12, v3
    v_mul_u32_u24 v13, 896, v13
    v_add_u32 v12, v12, v13
    v_mov_b32 v252, 0
    v_mov_b32 v253, 0
    buffer_load_short_d16_hi v252, v12, s[40:43], 0 offen
    buffer_load_short_d16_hi v253, v12, s[40:43], 0 offen offset:64
    v_and_b32 v12, 1, v0
    v_lshlrev_b32 v12, 3, v12
    v_lshl_add_u32 v12, v9, 6, v12
    v_lshrrev_b32 v13, 1, v10
    v_mul_u32_u24 v13, 28672, v13
    s_lshl_b32 s56, s3, 4
    s_add_u32 s56, s56, 65536
    v_add3_u32 v12, v12, v13, s56
    v_lshl_add_u32 v13, v10, 3, v11
    s_and_b32 s56, s3, 3
    s_lshl_b32 s56, s56, 5
    v_add_u32 v13, s56, v13
    v_mul_u32_u24 v14, 896, v9
    v_lshl_add_u32 v14, v10, 5, v14
    s_lshl_b32 s56, s3, 7
    s_add_u32 s56, s56, 122880
    v_add_u32 v14, s56, v14
    s_lshr_b32 s56, s3, 2
    s_lshl_b32 s47, s56, 3
    s_add_u32 s47, s47, s35
    s_lshl_b32 s46, s47, 11
    s_add_u32 s46, s46, 98304
    s_lshl_b32 s47, s47, 15
    s_and_b32 s57, s3, 3
    s_lshl_b32 s44, s57, 9
    s_add_u32 s47, s47, s44
    s_add_u32 s47, s47, 131072
    v_mul_u32_u24 v8, 6144, v1
    v_lshl_add_u32 v8, v2, 4, v8
    v_add_u32 v15, 4096, v8
    v_mul_u32_u24 v16, 3, v1
    v_min_u32 v17, 11, v2
    v_add_u32 v16, v16, v17
    v_subrev_u32 v17, 12, v16
    v_min_u32 v16, v16, v17
    v_lshlrev_b32 v16, 7, v16
    v_and_b32 v17, 8, v2
    v_lshl_add_u32 v17, v1, 1, v17
    v_and_b32 v9, 6, v2
    v_lshl_add_u32 v17, v9, 4, v17
    v_and_b32 v9, 1, v2
    v_lshl_add_u32 v17, v9, 9, v17
    s_mul_i32 s56, s56, 1088
    s_lshl_b32 s44, s57, 7
    s_add_u32 s56, s56, s44
    v_add3_u32 v17, v17, s56, v3
    v_mul_u32_u24 v18, 1088, v9
    v_add_u32 v18, v18, v22
    s_mul_i32 s44, s35, 28
    s_lshl_b32 s56, s33, 2
    s_add_u32 s44, s44, s56
    s_add_u32 s44, s44, s57
    s_lshl_b32 s44, s44, 7
    s_add_u32 s44, s44, 40960
    s_mul_i32 s61, s65, 3584
    s_lshl_b32 s56, s3, 9
    s_add_u32 s61, s61, s56
    s_add_u32 s61, s61, 655360
    v_lshl_add_u32 v19, v2, 6, v21
    v_lshlrev_b32 v245, 7, v1
    v_lshl_add_u32 v245, v2, 4, v245
    s_add_u32 s45, s56, 40960
    v_mul_u32_u24 v249, 7168, v1
    v_lshl_add_u32 v249, v2, 4, v249
    v_mul_u32_u24 v250, 960, v9
    v_add_u32 v250, v250, v22
    v_lshl_add_u32 v23, v9, 6, v22
    v_and_b32 v251, 14, v2
    v_lshlrev_b32 v251, 4, v251
    v_lshl_add_u32 v251, v9, 8, v251
    v_add_u32 v251, v251, v3
    v_and_b32 v247, 4, v2
    v_lshlrev_b32 v247, 6, v247
    v_lshl_add_u32 v247, v1, 3, v247
    s_lshl_b32 s56, s3, 5
    v_add3_u32 v247, v247, s56, v3
    v_and_b32 v254, 6, v2
    v_lshl_add_u32 v254, v9, 6, v254
    v_lshl_add_u32 v254, v1, 3, v254
    s_lshl_b32 s56, s3, 4
    v_add3_u32 v254, v254, s56, v3
    s_mov_b32 s20, 0x00110011
    s_mov_b32 s21, s20
    s_mov_b32 s66, 0x00ff00ff
    s_mov_b32 s67, s66
    s_mov_b32 s34, 0x00030003
    s_mov_b32 s35, s34
    s_mov_b32 s10, 0x000c000c
    s_mov_b32 s11, s10
    s_mov_b32 s12, 0x00300030
    s_mov_b32 s13, s12
    s_mov_b32 s62, 0x00c000c0
    s_mov_b32 s63, s62
    v_mov_b32 v246, 0xc0135761
    s_mov_b32 s60, 0xbdd2d3e8
    v_mov_b32 v216, 0
    v_mov_b32 v217, 0
    v_mov_b32 v218, 0
    v_mov_b32 v219, 0
    v_mov_b32 v220, 0
    v_mov_b32 v221, 0
    v_mov_b32 v222, 0
    v_mov_b32 v223, 0
    v_mov_b32 v224, 0
    v_mov_b32 v225, 0
    v_mov_b32 v226, 0
    v_mov_b32 v227, 0
    v_mov_b32 v228, 0
    v_mov_b32 v229, 0
    v_mov_b32 v230, 0
    v_mov_b32 v231, 0
    s_lshr_b32 s19, s65, 1
    s_lshl_b32 s18, s19, 7
    s_and_b32 s56, s65, 1
    s_lshl_b32 s57, s56, 4
    s_add_u32 s18, s18, s57
    s_add_u32 s18, s18, 655360
    v_lshrrev_b32 v9, 2, v0
    v_mul_u32_u24 v200, 3584, v9
    v_lshl_add_u32 v200, v10, 5, v200
    v_cmp_gt_u32 vcc, 8, v9
    v_add_u32 v201, 57344, v200
    v_add_u32 v202, 114688, v200
    v_add_u32 v203, 172032, v200
    v_cndmask_b32 v203, v200, v203, vcc
    v_cndmask_b32 v204, 0, 1.0, vcc
    v_mov_b32 v205, 0
    v_mov_b32 v208, 0
    v_lshlrev_b32 v206, 3, v10
    v_lshl_add_u32 v206, v1, 1, v206
    s_lshl_b32 s19, s19, 5
    s_mul_i32 s57, s56, 960
    s_add_u32 s57, s57, s19
    v_add3_u32 v207, v206, s57, v3
    s_mul_i32 s56, s56, 896
    s_add_u32 s19, s19, s56
    s_mov_b32 s40, s22
    s_mov_b32 s41, s23
    s_mov_b32 s16, 0x000f000f
    s_mov_b32 s17, s16
    s_waitcnt vmcnt(0)
    s_barrier
    ds_read_b64_tr_b16 v[120:121], v14 offset:0
    ds_read_b64_tr_b16 v[122:123], v14 offset:3584
    ds_read_b64_tr_b16 v[124:125], v14 offset:8
    ds_read_b64_tr_b16 v[126:127], v14 offset:3592
    ds_read_b64_tr_b16 v[128:129], v14 offset:16
    ds_read_b64_tr_b16 v[130:131], v14 offset:3600
    ds_read_b64_tr_b16 v[132:133], v14 offset:24
    ds_read_b64_tr_b16 v[134:135], v14 offset:3608
    s_cmp_ge_u32 s3, 4
    s_cbranch_scc1 L_s6
    ds_read_b64_tr_b16 v[136:137], v12 offset:0
    ds_read_b64_tr_b16 v[138:139], v12 offset:256
    ds_read_b64_tr_b16 v[140:141], v12 offset:2048
    ds_read_b64_tr_b16 v[142:143], v12 offset:2304
    ds_read_b64_tr_b16 v[144:145], v12 offset:4096
    ds_read_b64_tr_b16 v[146:147], v12 offset:4352
    ds_read_b64_tr_b16 v[148:149], v12 offset:6144
    ds_read_b64_tr_b16 v[150:151], v12 offset:6400
    ds_read_b64_tr_b16 v[152:153], v12 offset:8192
    ds_read_b64_tr_b16 v[154:155], v12 offset:8448
    ds_read_b64_tr_b16 v[156:157], v12 offset:10240
    ds_read_b64_tr_b16 v[158:159], v12 offset:10496
    ds_read_b64_tr_b16 v[160:161], v12 offset:12288
    ds_read_b64_tr_b16 v[162:163], v12 offset:12544
    ds_read_b64_tr_b16 v[164:165], v12 offset:14336
    ds_read_b64_tr_b16 v[166:167], v12 offset:14592
    ds_read_b64_tr_b16 v[168:169], v12 offset:16384
    ds_read_b64_tr_b16 v[170:171], v12 offset:16640
    ds_read_b64_tr_b16 v[172:173], v12 offset:18432
    ds_read_b64_tr_b16 v[174:175], v12 offset:18688
    ds_read_b64_tr_b16 v[176:177], v12 offset:20480
    ds_read_b64_tr_b16 v[178:179], v12 offset:20736
    ds_read_b64_tr_b16 v[180:181], v12 offset:22528
    ds_read_b64_tr_b16 v[182:183], v12 offset:22784
    ds_read_b64_tr_b16 v[184:185], v12 offset:24576
    ds_read_b64_tr_b16 v[186:187], v12 offset:24832
    ds_read_b64_tr_b16 v[188:189], v12 offset:26624
    ds_read_b64_tr_b16 v[190:191], v12 offset:26880
    v_mov_b32 v56, 0x3f803f80
    v_mov_b32 v57, v56
    v_mov_b32 v58, v56
    v_mov_b32 v59, v56
    s_nop 1
    s_waitcnt lgkmcnt(0)
    v_mfma_f32_16x16x32_bf16 v[24:27], v[136:139], v[56:59], 0
    v_mfma_f32_16x16x32_bf16 v[24:27], v[140:143], v[56:59], v[24:27]
    v_mfma_f32_16x16x32_bf16 v[24:27], v[144:147], v[56:59], v[24:27]
    v_mfma_f32_16x16x32_bf16 v[24:27], v[148:151], v[56:59], v[24:27]
    v_mfma_f32_16x16x32_bf16 v[24:27], v[152:155], v[56:59], v[24:27]
    v_mfma_f32_16x16x32_bf16 v[24:27], v[156:159], v[56:59], v[24:27]
    v_mfma_f32_16x16x32_bf16 v[24:27], v[160:163], v[56:59], v[24:27]
    v_mfma_f32_16x16x32_bf16 v[24:27], v[164:167], v[56:59], v[24:27]
    v_mfma_f32_16x16x32_bf16 v[24:27], v[168:171], v[56:59], v[24:27]
    v_mfma_f32_16x16x32_bf16 v[24:27], v[172:175], v[56:59], v[24:27]
    v_mfma_f32_16x16x32_bf16 v[24:27], v[176:179], v[56:59], v[24:27]
    v_mfma_f32_16x16x32_bf16 v[24:27], v[180:183], v[56:59], v[24:27]
    v_mfma_f32_16x16x32_bf16 v[24:27], v[184:187], v[56:59], v[24:27]
    v_mfma_f32_16x16x32_bf16 v[24:27], v[188:191], v[56:59], v[24:27]
    s_nop 7
    v_cndmask_b32 v24, v24, v25, s[48:49]
    v_cndmask_b32 v26, v26, v27, s[48:49]
    v_cndmask_b32 v244, v24, v26, s[50:51]
    s_branch L_s7
L_s6:
    ds_read_b64_tr_b16 v[136:137], v13 offset:0
    ds_read_b64_tr_b16 v[138:139], v13 offset:512
    ds_read_b64_tr_b16 v[140:141], v13 offset:4096
    ds_read_b64_tr_b16 v[142:143], v13 offset:4608
    ds_read_b64_tr_b16 v[144:145], v13 offset:8192
    ds_read_b64_tr_b16 v[146:147], v13 offset:8704
    ds_read_b64_tr_b16 v[148:149], v13 offset:12288
    ds_read_b64_tr_b16 v[150:151], v13 offset:12800
    ds_read_b64_tr_b16 v[152:153], v13 offset:16384
    ds_read_b64_tr_b16 v[154:155], v13 offset:16896
    ds_read_b64_tr_b16 v[156:157], v13 offset:20480
    ds_read_b64_tr_b16 v[158:159], v13 offset:20992
    ds_read_b64_tr_b16 v[160:161], v13 offset:24576
    ds_read_b64_tr_b16 v[162:163], v13 offset:25088
    ds_read_b64_tr_b16 v[164:165], v13 offset:28672
    ds_read_b64_tr_b16 v[166:167], v13 offset:29184
    ds_read_b64_tr_b16 v[168:169], v13 offset:32768
    ds_read_b64_tr_b16 v[170:171], v13 offset:33280
    ds_read_b64_tr_b16 v[172:173], v13 offset:36864
    ds_read_b64_tr_b16 v[174:175], v13 offset:37376
    ds_read_b64_tr_b16 v[176:177], v13 offset:40960
    ds_read_b64_tr_b16 v[178:179], v13 offset:41472
    ds_read_b64_tr_b16 v[180:181], v13 offset:45056
    ds_read_b64_tr_b16 v[182:183], v13 offset:45568
    ds_read_b64_tr_b16 v[184:185], v13 offset:49152
    ds_read_b64_tr_b16 v[186:187], v13 offset:49664
    ds_read_b64_tr_b16 v[188:189], v13 offset:53248
    ds_read_b64_tr_b16 v[190:191], v13 offset:53760
    ds_read_b64_tr_b16 v[192:193], v13 offset:57344
    ds_read_b64_tr_b16 v[194:195], v13 offset:57856
    ds_read_b64_tr_b16 v[196:197], v13 offset:61440
    ds_read_b64_tr_b16 v[198:199], v13 offset:61952
L_s7:
Lg_23:
    buffer_load_dwordx4 v[24:27], v16, s[52:55], s46 offen offset:0 sc1
    s_waitcnt vmcnt(0)
    v_xor_b32 v24, s28, v24
    v_xor_b32 v25, s29, v25
    v_xor_b32 v26, s30, v26
    v_xor_b32 v27, s31, v27
    v_or3_b32 v20, v24, v25, v26
    v_bitop3_b32 v20, v20, v27, s58 bitop3:0xa8
    v_cmp_ne_u32 vcc, 0, v20
    s_cbranch_vccz Lg_24
    s_sleep 32
    s_sub_u32 s64, s64, 17
    s_cbranch_scc0 Lg_23
    s_mov_b32 s64, 0
Lg_24:
    v_cmp_gt_u32 vcc, 12, v2
    v_mov_b32 v28, v24
    v_mov_b32 v29, v25
    v_cndmask_b32 v26, 0, v26, vcc
    v_cndmask_b32 v27, 0, v27, vcc
    v_max_f32_dpp v28, v28, v28 row_ror:1 row_mask:0xf bank_mask:0xf
    v_max_f32_dpp v29, v29, v29 row_ror:1 row_mask:0xf bank_mask:0xf
    s_nop 0
    v_max_f32_dpp v28, v28, v28 row_ror:2 row_mask:0xf bank_mask:0xf
    v_max_f32_dpp v29, v29, v29 row_ror:2 row_mask:0xf bank_mask:0xf
    s_nop 0
    v_max_f32_dpp v28, v28, v28 row_ror:4 row_mask:0xf bank_mask:0xf
    v_max_f32_dpp v29, v29, v29 row_ror:4 row_mask:0xf bank_mask:0xf
    s_nop 0
    v_max_f32_dpp v28, v28, v28 row_ror:8 row_mask:0xf bank_mask:0xf
    v_max_f32_dpp v29, v29, v29 row_ror:8 row_mask:0xf bank_mask:0xf
    s_nop 0
    v_sub_f32 v24, v24, v28
    v_sub_f32 v25, v25, v29
    v_mul_f32 v24, 0x3db8aa3b, v24
    v_mul_f32 v25, 0x3db8aa3b, v25
    v_exp_f32 v24, v24
    v_exp_f32 v25, v25
    s_nop 0
    v_mul_f32 v26, v24, v26
    v_mul_f32 v27, v25, v27
    s_nop 0
    v_add_f32_dpp v26, v26, v26 row_ror:1 row_mask:0xf bank_mask:0xf
    v_add_f32_dpp v27, v27, v27 row_ror:1 row_mask:0xf bank_mask:0xf
    s_nop 0
    v_add_f32_dpp v26, v26, v26 row_ror:2 row_mask:0xf bank_mask:0xf
    v_add_f32_dpp v27, v27, v27 row_ror:2 row_mask:0xf bank_mask:0xf
    s_nop 0
    v_add_f32_dpp v26, v26, v26 row_ror:4 row_mask:0xf bank_mask:0xf
    v_add_f32_dpp v27, v27, v27 row_ror:4 row_mask:0xf bank_mask:0xf
    s_nop 0
    v_add_f32_dpp v26, v26, v26 row_ror:8 row_mask:0xf bank_mask:0xf
    v_add_f32_dpp v27, v27, v27 row_ror:8 row_mask:0xf bank_mask:0xf
    v_rcp_f32 v26, v26
    v_rcp_f32 v27, v27
    s_nop 0
    v_mul_f32 v24, v24, v26
    v_mul_f32 v25, v25, v27
    s_nop 1
    v_mov_b32_dpp v210, v24 row_newbcast:0 row_mask:0xf bank_mask:0xf
    v_mov_b32_dpp v212, v24 row_newbcast:1 row_mask:0xf bank_mask:0xf
    v_mov_b32_dpp v214, v24 row_newbcast:2 row_mask:0xf bank_mask:0xf
    v_mov_b32_dpp v211, v25 row_newbcast:0 row_mask:0xf bank_mask:0xf
    v_mov_b32_dpp v213, v25 row_newbcast:1 row_mask:0xf bank_mask:0xf
    v_mov_b32_dpp v215, v25 row_newbcast:2 row_mask:0xf bank_mask:0xf
    s_mov_b32 s56, 0xaaaaaaaa
    s_mov_b32 s57, s56
    v_cndmask_b32 v210, v210, v211, s[56:57]
    v_cndmask_b32 v212, v212, v213, s[56:57]
    v_cndmask_b32 v214, v214, v215, s[56:57]
    s_mov_b32 s56, 0x00010001
    s_mov_b32 s57, s56
    s_mov_b64 exec, s[56:57]
Ls_25:
    buffer_load_dwordx4 v[24:27], v8, s[52:55], s47 offen offset:0 sc1
    s_waitcnt vmcnt(0)
    v_xor_b32 v24, s28, v24
    v_xor_b32 v25, s29, v25
    v_xor_b32 v26, s30, v26
    v_xor_b32 v27, s31, v27
    v_or3_b32 v20, v24, v25, v26
    v_bitop3_b32 v20, v20, v27, s58 bitop3:0xa8
    v_cmp_ne_u32 vcc, 0, v20
    s_cmp_lg_u64 vcc, exec
    s_cbranch_scc1 Ls_26
    s_sleep 6
    s_sub_u32 s64, s64, 4
    s_cbranch_scc0 Ls_25
    s_mov_b32 s64, 0
Ls_26:
    s_mov_b64 s[4:5], -1
    s_mov_b64 s[6:7], -1
    s_mov_b64 s[8:9], -1
Lg_27:
    s_mov_b64 exec, s[4:5]
    s_cbranch_execz Lk_30
    buffer_load_dwordx4 v[24:27], v8, s[52:55], s47 offen offset:0 sc1
    buffer_load_dwordx4 v[28:31], v8, s[52:55], s47 offen offset:256 sc1
Lk_30:
    s_mov_b64 exec, s[6:7]
    s_cbranch_execz Lk_31
    buffer_load_dwordx4 v[32:35], v8, s[52:55], s47 offen offset:2048 sc1
    buffer_load_dwordx4 v[36:39], v8, s[52:55], s47 offen offset:2304 sc1
Lk_31:
    s_mov_b64 exec, s[8:9]
    s_cbranch_execz Lk_32
    buffer_load_dwordx4 v[40:43], v15, s[52:55], s47 offen offset:0 sc1
    buffer_load_dwordx4 v[44:47], v15, s[52:55], s47 offen offset:256 sc1
Lk_32:
    s_waitcnt vmcnt(0)
    s_mov_b64 exec, s[4:5]
    s_cbranch_execz Lk_33
    v_xor_b32 v24, s28, v24
    v_xor_b32 v25, s29, v25
    v_xor_b32 v26, s30, v26
    v_xor_b32 v27, s31, v27
    v_xor_b32 v28, s28, v28
    v_xor_b32 v29, s29, v29
    v_xor_b32 v30, s30, v30
    v_xor_b32 v31, s31, v31
    v_or3_b32 v20, v24, v25, v26
    v_or3_b32 v20, v20, v27, v28
    v_or3_b32 v20, v20, v29, v30
    v_bitop3_b32 v20, v20, v31, s58 bitop3:0xa8
    v_cmp_ne_u32 s[4:5], 0, v20
Lk_33:
    s_mov_b64 exec, s[6:7]
    s_cbranch_execz Lk_34
    v_xor_b32 v32, s28, v32
    v_xor_b32 v33, s29, v33
    v_xor_b32 v34, s30, v34
    v_xor_b32 v35, s31, v35
    v_xor_b32 v36, s28, v36
    v_xor_b32 v37, s29, v37
    v_xor_b32 v38, s30, v38
    v_xor_b32 v39, s31, v39
    v_or3_b32 v20, v32, v33, v34
    v_or3_b32 v20, v20, v35, v36
    v_or3_b32 v20, v20, v37, v38
    v_bitop3_b32 v20, v20, v39, s58 bitop3:0xa8
    v_cmp_ne_u32 s[6:7], 0, v20
Lk_34:
    s_mov_b64 exec, s[8:9]
    s_cbranch_execz Lk_35
    v_xor_b32 v40, s28, v40
    v_xor_b32 v41, s29, v41
    v_xor_b32 v42, s30, v42
    v_xor_b32 v43, s31, v43
    v_xor_b32 v44, s28, v44
    v_xor_b32 v45, s29, v45
    v_xor_b32 v46, s30, v46
    v_xor_b32 v47, s31, v47
    v_or3_b32 v20, v40, v41, v42
    v_or3_b32 v20, v20, v43, v44
    v_or3_b32 v20, v20, v45, v46
    v_bitop3_b32 v20, v20, v47, s58 bitop3:0xa8
    v_cmp_ne_u32 s[8:9], 0, v20
Lk_35:
    s_or_b64 s[14:15], s[4:5], s[6:7]
    s_or_b64 s[14:15], s[14:15], s[8:9]
    s_cbranch_scc0 Lg_28
    s_sub_u32 s64, s64, 1
    s_cbranch_scc0 Lg_27
    s_mov_b32 s64, 0
Lg_28:
    s_mov_b64 exec, -1
Lg_29:
    v_pk_mul_f32 v[24:25], v[24:25], v[210:211] op_sel_hi:[1,0]
    v_pk_mul_f32 v[26:27], v[26:27], v[210:211] op_sel_hi:[1,0]
    v_pk_mul_f32 v[28:29], v[28:29], v[210:211] op_sel_hi:[1,0]
    v_pk_mul_f32 v[30:31], v[30:31], v[210:211] op_sel_hi:[1,0]
    v_pk_fma_f32 v[24:25], v[32:33], v[212:213], v[24:25] op_sel_hi:[1,0,1]
    v_pk_fma_f32 v[26:27], v[34:35], v[212:213], v[26:27] op_sel_hi:[1,0,1]
    v_pk_fma_f32 v[28:29], v[36:37], v[212:213], v[28:29] op_sel_hi:[1,0,1]
    v_pk_fma_f32 v[30:31], v[38:39], v[212:213], v[30:31] op_sel_hi:[1,0,1]
    v_pk_fma_f32 v[24:25], v[40:41], v[214:215], v[24:25] op_sel_hi:[1,0,1]
    v_pk_fma_f32 v[26:27], v[42:43], v[214:215], v[26:27] op_sel_hi:[1,0,1]
    v_pk_fma_f32 v[28:29], v[44:45], v[214:215], v[28:29] op_sel_hi:[1,0,1]
    v_pk_fma_f32 v[30:31], v[46:47], v[214:215], v[30:31] op_sel_hi:[1,0,1]
    v_permlane16_swap_b32 v24, v25
    v_permlane16_swap_b32 v26, v27
    v_permlane16_swap_b32 v28, v29
    v_permlane16_swap_b32 v30, v31
    v_add_f32 v24, v24, v25
    v_add_f32 v26, v26, v27
    v_add_f32 v28, v28, v29
    v_add_f32 v30, v30, v31
    v_permlane32_swap_b32 v24, v26
    s_nop 0
    v_permlane32_swap_b32 v28, v30
    v_add_f32 v24, v24, v26
    v_add_f32 v28, v28, v30
    v_cvt_pk_bf16_f32 v24, v24, v28
    ds_write_b16 v17, v24 offset:0
    ds_write_b16_d16_hi v17, v24 offset:16
    s_cmp_lt_u32 s3, 4
    s_waitcnt lgkmcnt(0)
    s_barrier
    s_cbranch_scc1 L_s8
    ds_read_b128 v[56:59], v18 offset:0
    ds_read_b128 v[60:63], v18 offset:64
    ds_read_b128 v[64:67], v18 offset:128
    ds_read_b128 v[68:71], v18 offset:192
    ds_read_b128 v[72:75], v18 offset:256
    s_waitcnt lgkmcnt(4)
    v_mfma_f32_16x16x32_bf16 v[24:27], v[136:139], v[56:59], 0
    ds_read_b128 v[76:79], v18 offset:320
    s_waitcnt lgkmcnt(4)
    v_mfma_f32_16x16x32_bf16 v[24:27], v[140:143], v[60:63], v[24:27]
    ds_read_b128 v[80:83], v18 offset:384
    s_waitcnt lgkmcnt(4)
    v_mfma_f32_16x16x32_bf16 v[24:27], v[144:147], v[64:67], v[24:27]
    ds_read_b128 v[84:87], v18 offset:448
    s_waitcnt lgkmcnt(4)
    v_mfma_f32_16x16x32_bf16 v[24:27], v[148:151], v[68:71], v[24:27]
    ds_read_b128 v[88:91], v18 offset:512
    s_waitcnt lgkmcnt(4)
    v_mfma_f32_16x16x32_bf16 v[24:27], v[152:155], v[72:75], v[24:27]
    ds_read_b128 v[92:95], v18 offset:576
    s_waitcnt lgkmcnt(4)
    v_mfma_f32_16x16x32_bf16 v[24:27], v[156:159], v[76:79], v[24:27]
    ds_read_b128 v[96:99], v18 offset:640
    s_waitcnt lgkmcnt(4)
    v_mfma_f32_16x16x32_bf16 v[24:27], v[160:163], v[80:83], v[24:27]
    ds_read_b128 v[100:103], v18 offset:704
    s_waitcnt lgkmcnt(4)
    v_mfma_f32_16x16x32_bf16 v[24:27], v[164:167], v[84:87], v[24:27]
    ds_read_b128 v[104:107], v18 offset:768
    s_waitcnt lgkmcnt(4)
    v_mfma_f32_16x16x32_bf16 v[24:27], v[168:171], v[88:91], v[24:27]
    ds_read_b128 v[108:111], v18 offset:832
    s_waitcnt lgkmcnt(4)
    v_mfma_f32_16x16x32_bf16 v[24:27], v[172:175], v[92:95], v[24:27]
    ds_read_b128 v[112:115], v18 offset:896
    s_waitcnt lgkmcnt(4)
    v_mfma_f32_16x16x32_bf16 v[24:27], v[176:179], v[96:99], v[24:27]
    ds_read_b128 v[116:119], v18 offset:960
    s_waitcnt lgkmcnt(4)
    v_mfma_f32_16x16x32_bf16 v[24:27], v[180:183], v[100:103], v[24:27]
    s_waitcnt lgkmcnt(3)
    v_mfma_f32_16x16x32_bf16 v[24:27], v[184:187], v[104:107], v[24:27]
    s_waitcnt lgkmcnt(2)
    v_mfma_f32_16x16x32_bf16 v[24:27], v[188:191], v[108:111], v[24:27]
    s_waitcnt lgkmcnt(1)
    v_mfma_f32_16x16x32_bf16 v[24:27], v[192:195], v[112:115], v[24:27]
    s_waitcnt lgkmcnt(0)
    v_mfma_f32_16x16x32_bf16 v[24:27], v[196:199], v[116:119], v[24:27]
    s_mov_b64 exec, s[34:35]
    s_nop 6
    v_and_or_b32 v24, v24, s59, v4
    v_and_or_b32 v25, v25, s59, v5
    v_and_or_b32 v26, v26, s59, v6
    v_and_or_b32 v27, v27, s59, v7
    buffer_store_dwordx4 v[24:27], v19, s[52:55], s44 offen sc1
    s_mov_b64 exec, -1
    s_waitcnt vmcnt(0)
L_s8:
    s_cmp_eq_u32 s3, 7
    s_barrier
    s_cbranch_scc1 L_final
    buffer_load_dwordx4 v[28:31], v249, s[52:55], s45 offen offset:0 sc1
    buffer_load_dwordx4 v[32:35], v249, s[52:55], s45 offen offset:256 sc1
    buffer_load_dwordx4 v[36:39], v249, s[52:55], s45 offen offset:3584 sc1
    buffer_load_dwordx4 v[40:43], v249, s[52:55], s45 offen offset:3840 sc1
    s_waitcnt vmcnt(2)
    v_xor_b32 v28, s28, v28
    v_xor_b32 v29, s29, v29
    v_xor_b32 v30, s30, v30
    v_xor_b32 v31, s31, v31
    v_xor_b32 v32, s28, v32
    v_xor_b32 v33, s29, v33
    v_xor_b32 v34, s30, v34
    v_xor_b32 v35, s31, v35
    v_or3_b32 v20, v28, v29, v30
    v_or3_b32 v20, v20, v31, v32
    v_or3_b32 v20, v20, v33, v34
    v_bitop3_b32 v20, v20, v35, s58 bitop3:0xa8
    v_cmp_ne_u32 s[4:5], 0, v20
    s_waitcnt vmcnt(0)
    v_xor_b32 v36, s28, v36
    v_xor_b32 v37, s29, v37
    v_xor_b32 v38, s30, v38
    v_xor_b32 v39, s31, v39
    v_xor_b32 v40, s28, v40
    v_xor_b32 v41, s29, v41
    v_xor_b32 v42, s30, v42
    v_xor_b32 v43, s31, v43
    v_or3_b32 v20, v36, v37, v38
    v_or3_b32 v20, v20, v39, v40
    v_or3_b32 v20, v20, v41, v42
    v_bitop3_b32 v20, v20, v43, s58 bitop3:0xa8
    v_cmp_ne_u32 s[6:7], 0, v20
    s_or_b64 s[14:15], s[4:5], s[6:7]
    s_cbranch_scc0 Lg_38
Lg_36:
    s_mov_b64 exec, s[4:5]
    s_cbranch_execz Lk_39
    buffer_load_dwordx4 v[28:31], v249, s[52:55], s45 offen offset:0 sc1
    buffer_load_dwordx4 v[32:35], v249, s[52:55], s45 offen offset:256 sc1
Lk_39:
    s_mov_b64 exec, s[6:7]
    s_cbranch_execz Lk_40
    buffer_load_dwordx4 v[36:39], v249, s[52:55], s45 offen offset:3584 sc1
    buffer_load_dwordx4 v[40:43], v249, s[52:55], s45 offen offset:3840 sc1
Lk_40:
    s_waitcnt vmcnt(0)
    s_mov_b64 exec, s[4:5]
    s_cbranch_execz Lk_41
    v_xor_b32 v28, s28, v28
    v_xor_b32 v29, s29, v29
    v_xor_b32 v30, s30, v30
    v_xor_b32 v31, s31, v31
    v_xor_b32 v32, s28, v32
    v_xor_b32 v33, s29, v33
    v_xor_b32 v34, s30, v34
    v_xor_b32 v35, s31, v35
    v_or3_b32 v20, v28, v29, v30
    v_or3_b32 v20, v20, v31, v32
    v_or3_b32 v20, v20, v33, v34
    v_bitop3_b32 v20, v20, v35, s58 bitop3:0xa8
    v_cmp_ne_u32 s[4:5], 0, v20
Lk_41:
    s_mov_b64 exec, s[6:7]
    s_cbranch_execz Lk_42
    v_xor_b32 v36, s28, v36
    v_xor_b32 v37, s29, v37
    v_xor_b32 v38, s30, v38
    v_xor_b32 v39, s31, v39
    v_xor_b32 v40, s28, v40
    v_xor_b32 v41, s29, v41
    v_xor_b32 v42, s30, v42
    v_xor_b32 v43, s31, v43
    v_or3_b32 v20, v36, v37, v38
    v_or3_b32 v20, v20, v39, v40
    v_or3_b32 v20, v20, v41, v42
    v_bitop3_b32 v20, v20, v43, s58 bitop3:0xa8
    v_cmp_ne_u32 s[6:7], 0, v20
Lk_42:
    s_or_b64 s[14:15], s[4:5], s[6:7]
    s_cbranch_scc0 Lg_37
    s_sub_u32 s64, s64, 1
    s_cbranch_scc0 Lg_36
    s_mov_b32 s64, 0
Lg_37:
    s_mov_b64 exec, -1
Lg_38:
    v_pk_add_f32 v[28:29], v[28:29], v[36:37]
    v_pk_add_f32 v[30:31], v[30:31], v[38:39]
    v_pk_add_f32 v[32:33], v[32:33], v[40:41]
    v_pk_add_f32 v[34:35], v[34:35], v[42:43]
    v_permlane16_swap_b32 v28, v29
    v_permlane16_swap_b32 v30, v31
    v_permlane16_swap_b32 v32, v33
    v_permlane16_swap_b32 v34, v35
    v_add_f32 v28, v28, v29
    v_add_f32 v30, v30, v31
    v_add_f32 v32, v32, v33
    v_add_f32 v34, v34, v35
    v_permlane32_swap_b32 v28, v30
    s_nop 0
    v_permlane32_swap_b32 v32, v34
    v_add_f32 v28, v28, v30
    v_add_f32 v32, v32, v34
    v_cvt_pk_bf16_f32 v28, v28, v32
    v_lshlrev_b32 v29, 16, v28
    v_and_b32 v28, 0xffff0000, v28
    v_add_f32 v29, v252, v29
    v_add_f32 v28, v253, v28
    v_cvt_pk_bf16_f32 v28, v29, v28
    ds_write_b16 v248, v28 offset:2304
    ds_write_b16_d16_hi v248, v28 offset:2368
    v_lshlrev_b32 v29, 16, v28
    v_and_b32 v30, 0xffff0000, v28
    v_add_f32 v32, v29, v30
    v_mul_f32 v33, v29, v29
    v_fmac_f32 v33, v30, v30
    v_add_f32_dpp v32, v32, v32 quad_perm:[1,0,3,2] row_mask:0xf bank_mask:0xf
    s_nop 0
    v_add_f32_dpp v33, v33, v33 quad_perm:[1,0,3,2] row_mask:0xf bank_mask:0xf
    v_add_f32_dpp v32, v32, v32 quad_perm:[2,3,0,1] row_mask:0xf bank_mask:0xf
    s_nop 0
    v_add_f32_dpp v33, v33, v33 quad_perm:[2,3,0,1] row_mask:0xf bank_mask:0xf
    v_add_f32_dpp v32, v32, v32 row_ror:8 row_mask:0xf bank_mask:0xf
    s_nop 0
    v_add_f32_dpp v33, v33, v33 row_ror:8 row_mask:0xf bank_mask:0xf
    s_mov_b64 exec, s[20:21]
    ds_write_b64 v247, v[32:33] offset:4480
    s_mov_b64 exec, -1
    s_cmp_ge_u32 s3, 4
    s_waitcnt lgkmcnt(0)
    s_barrier
    s_cbranch_scc1 L_f2
    ds_read_b128 v[32:35], v251 offset:4480
    ds_read_b128 v[36:39], v251 offset:4496
    ds_read_b128 v[56:59], v250 offset:2304
    ds_read_b128 v[60:63], v250 offset:2368
    ds_read_b128 v[64:67], v250 offset:2432
    ds_read_b128 v[68:71], v250 offset:2496
    ds_read_b128 v[72:75], v250 offset:2560
    s_waitcnt lgkmcnt(4)
    v_mfma_f32_16x16x32_bf16 v[24:27], v[136:139], v[56:59], 0
    v_pk_add_f32 v[32:33], v[32:33], v[34:35]
    v_pk_add_f32 v[36:37], v[36:37], v[38:39]
    ds_read_b128 v[76:79], v250 offset:2624
    s_waitcnt lgkmcnt(4)
    v_mfma_f32_16x16x32_bf16 v[24:27], v[140:143], v[60:63], v[24:27]
    v_pk_add_f32 v[40:41], v[32:33], v[36:37]
    ds_read_b128 v[80:83], v250 offset:2688
    s_waitcnt lgkmcnt(4)
    v_mfma_f32_16x16x32_bf16 v[24:27], v[144:147], v[64:67], v[24:27]
    v_add_f32_dpp v40, v40, v40 row_ror:2 row_mask:0xf bank_mask:0xf
    v_add_f32_dpp v41, v41, v41 row_ror:2 row_mask:0xf bank_mask:0xf
    ds_read_b128 v[84:87], v250 offset:2752
    s_waitcnt lgkmcnt(4)
    v_mfma_f32_16x16x32_bf16 v[24:27], v[148:151], v[68:71], v[24:27]
    v_add_f32_dpp v40, v40, v40 row_ror:4 row_mask:0xf bank_mask:0xf
    v_add_f32_dpp v41, v41, v41 row_ror:4 row_mask:0xf bank_mask:0xf
    ds_read_b128 v[88:91], v250 offset:2816
    s_waitcnt lgkmcnt(4)
    v_mfma_f32_16x16x32_bf16 v[24:27], v[152:155], v[72:75], v[24:27]
    v_add_f32_dpp v40, v40, v40 row_ror:8 row_mask:0xf bank_mask:0xf
    v_add_f32_dpp v41, v41, v41 row_ror:8 row_mask:0xf bank_mask:0xf
    ds_read_b128 v[92:95], v250 offset:2880
    s_waitcnt lgkmcnt(4)
    v_mfma_f32_16x16x32_bf16 v[24:27], v[156:159], v[76:79], v[24:27]
    v_mul_f32 v40, 0x3b124925, v40
    v_mul_f32 v41, 0x3b124925, v41
    ds_read_b128 v[96:99], v250 offset:2944
    s_waitcnt lgkmcnt(4)
    v_mfma_f32_16x16x32_bf16 v[24:27], v[160:163], v[80:83], v[24:27]
    v_fma_f32 v41, -v40, v40, v41
    v_max_f32 v41, 0, v41
    ds_read_b128 v[100:103], v250 offset:3008
    s_waitcnt lgkmcnt(4)
    v_mfma_f32_16x16x32_bf16 v[24:27], v[164:167], v[84:87], v[24:27]
    v_cvt_pk_bf16_f32 v44, v40, v41
    v_and_b32 v41, 0xffff0000, v44
    ds_read_b128 v[104:107], v250 offset:3072
    s_waitcnt lgkmcnt(4)
    v_mfma_f32_16x16x32_bf16 v[24:27], v[168:171], v[88:91], v[24:27]
    v_lshlrev_b32 v42, 16, v44
    v_add_f32 v41, 0x3727c5ac, v41
    ds_read_b128 v[108:111], v250 offset:3136
    s_waitcnt lgkmcnt(4)
    v_mfma_f32_16x16x32_bf16 v[24:27], v[172:175], v[92:95], v[24:27]
    v_cvt_pk_bf16_f32 v44, v41, v41
    v_lshlrev_b32 v41, 16, v44
    s_waitcnt lgkmcnt(3)
    v_mfma_f32_16x16x32_bf16 v[24:27], v[176:179], v[96:99], v[24:27]
    v_sqrt_f32 v41, v41
    s_waitcnt lgkmcnt(2)
    v_mfma_f32_16x16x32_bf16 v[24:27], v[180:183], v[100:103], v[24:27]
    v_cvt_pk_bf16_f32 v44, v41, v41
    v_lshlrev_b32 v41, 16, v44
    s_waitcnt lgkmcnt(1)
    v_mfma_f32_16x16x32_bf16 v[24:27], v[184:187], v[104:107], v[24:27]
    v_rcp_f32 v43, v41
    s_waitcnt lgkmcnt(0)
    v_mfma_f32_16x16x32_bf16 v[24:27], v[188:191], v[108:111], v[24:27]
    s_nop 7
    v_cndmask_b32 v24, v24, v25, s[48:49]
    v_cndmask_b32 v26, v26, v27, s[48:49]
    v_cndmask_b32 v24, v24, v26, s[50:51]
    v_fma_f32 v24, -v244, v42, v24
    v_mul_f32 v24, v24, v43
    v_cvt_pk_bf16_f32 v24, v24, v24
    v_lshlrev_b32 v24, 16, v24
    v_mul_f32 v26, v24, v24
    v_fma_f32 v26, v26, s60, v246
    v_mul_f32 v26, v26, v24
    v_exp_f32 v26, v26
    v_mov_b32 v27, v24
    v_add_f32 v26, 1.0, v26
    v_rcp_f32 v26, v26
    v_permlane32_swap_b32 v27, v25
    v_mul_f32 v26, v26, v24
    v_cvt_pk_bf16_f32 v26, v26, v26
    v_lshlrev_b32 v26, 16, v26
    v_mul_f32 v26, v26, v25
    v_cvt_pk_bf16_f32 v26, v26, v26
    s_mov_b64 exec, 0x00ff00ff
    ds_write_b16 v254, v26 offset:4352
L_f2:
    s_mov_b64 exec, s[34:35]
    s_waitcnt lgkmcnt(0)
    s_barrier
    ds_read_b128 v[216:219], v23 offset:4352
    s_mov_b64 exec, s[10:11]
    ds_read_b128 v[220:223], v23 offset:4352
    s_mov_b64 exec, s[12:13]
    ds_read_b128 v[224:227], v23 offset:4352
    s_mov_b64 exec, s[62:63]
    ds_read_b128 v[228:231], v23 offset:4352
    s_mov_b64 exec, -1
    s_waitcnt lgkmcnt(3)
    v_mfma_f32_16x16x32_bf16 v[48:51], v[120:123], v[216:219], 0
    s_waitcnt lgkmcnt(2)
    v_mfma_f32_16x16x32_bf16 v[48:51], v[124:127], v[220:223], v[48:51]
    s_waitcnt lgkmcnt(1)
    v_mfma_f32_16x16x32_bf16 v[48:51], v[128:131], v[224:227], v[48:51]
    s_waitcnt lgkmcnt(0)
    v_mfma_f32_16x16x32_bf16 v[48:51], v[132:135], v[228:231], v[48:51]
    s_mov_b64 exec, s[66:67]
    s_nop 6
    v_and_or_b32 v48, v48, s59, v4
    v_and_or_b32 v49, v49, s59, v5
    v_and_or_b32 v50, v50, s59, v6
    v_and_or_b32 v51, v51, s59, v7
    buffer_store_dwordx4 v[48:51], v245, s[52:55], s61 offen sc1
    s_endpgm
L_final:
    s_barrier
    ds_read_u16_d16_hi v208, v207 offset:2304
    s_cmp_lg_u32 s65, 0
    s_cbranch_scc1 L_noE
    s_mov_b64 exec, 1
    buffer_store_dwordx4 v[4:7], v205, s[52:55], 0 offen offset:0
    s_mov_b64 exec, -1
L_noE:
    s_barrier
Ls_46:
    s_sleep 18
    buffer_load_dwordx4 v[24:27], v200, s[52:55], s18 offen offset:0 sc1
    buffer_load_dwordx4 v[28:31], v201, s[52:55], s18 offen offset:0 sc1
    buffer_load_dwordx4 v[32:35], v202, s[52:55], s18 offen offset:0 sc1
    buffer_load_dwordx4 v[36:39], v203, s[52:55], s18 offen offset:0 sc1
    s_waitcnt vmcnt(2)
    v_xor_b32 v24, s28, v24
    v_xor_b32 v25, s29, v25
    v_xor_b32 v26, s30, v26
    v_xor_b32 v27, s31, v27
    v_xor_b32 v28, s28, v28
    v_xor_b32 v29, s29, v29
    v_xor_b32 v30, s30, v30
    v_xor_b32 v31, s31, v31
    v_or3_b32 v20, v24, v25, v26
    v_or3_b32 v20, v20, v27, v28
    v_or3_b32 v20, v20, v29, v30
    v_bitop3_b32 v20, v20, v31, s58 bitop3:0xa8
    v_cmp_ne_u32 s[4:5], 0, v20
    s_waitcnt vmcnt(0)
    v_xor_b32 v32, s28, v32
    v_xor_b32 v33, s29, v33
    v_xor_b32 v34, s30, v34
    v_xor_b32 v35, s31, v35
    v_xor_b32 v36, s28, v36
    v_xor_b32 v37, s29, v37
    v_xor_b32 v38, s30, v38
    v_xor_b32 v39, s31, v39
    v_or3_b32 v20, v32, v33, v34
    v_or3_b32 v20, v20, v35, v36
    v_or3_b32 v20, v20, v37, v38
    v_bitop3_b32 v20, v20, v39, s58 bitop3:0xa8
    v_cmp_ne_u32 s[6:7], 0, v20
    s_or_b64 s[14:15], s[4:5], s[6:7]
    s_cbranch_scc0 Lg_45
    s_nand_b64 s[14:15], s[4:5], s[6:7]
    s_cbranch_scc1 Lg_43
    s_sub_u32 s64, s64, 10
    s_cbranch_scc0 Ls_46
    s_mov_b32 s64, 0
Lg_43:
    s_mov_b64 exec, s[4:5]
    s_cbranch_execz Lk_47
    buffer_load_dwordx4 v[24:27], v200, s[52:55], s18 offen offset:0 sc1
    buffer_load_dwordx4 v[28:31], v201, s[52:55], s18 offen offset:0 sc1
Lk_47:
    s_mov_b64 exec, s[6:7]
    s_cbranch_execz Lk_48
    buffer_load_dwordx4 v[32:35], v202, s[52:55], s18 offen offset:0 sc1
    buffer_load_dwordx4 v[36:39], v203, s[52:55], s18 offen offset:0 sc1
Lk_48:
    s_waitcnt vmcnt(0)
    s_mov_b64 exec, s[4:5]
    s_cbranch_execz Lk_49
    v_xor_b32 v24, s28, v24
    v_xor_b32 v25, s29, v25
    v_xor_b32 v26, s30, v26
    v_xor_b32 v27, s31, v27
    v_xor_b32 v28, s28, v28
    v_xor_b32 v29, s29, v29
    v_xor_b32 v30, s30, v30
    v_xor_b32 v31, s31, v31
    v_or3_b32 v20, v24, v25, v26
    v_or3_b32 v20, v20, v27, v28
    v_or3_b32 v20, v20, v29, v30
    v_bitop3_b32 v20, v20, v31, s58 bitop3:0xa8
    v_cmp_ne_u32 s[4:5], 0, v20
Lk_49:
    s_mov_b64 exec, s[6:7]
    s_cbranch_execz Lk_50
    v_xor_b32 v32, s28, v32
    v_xor_b32 v33, s29, v33
    v_xor_b32 v34, s30, v34
    v_xor_b32 v35, s31, v35
    v_xor_b32 v36, s28, v36
    v_xor_b32 v37, s29, v37
    v_xor_b32 v38, s30, v38
    v_xor_b32 v39, s31, v39
    v_or3_b32 v20, v32, v33, v34
    v_or3_b32 v20, v20, v35, v36
    v_or3_b32 v20, v20, v37, v38
    v_bitop3_b32 v20, v20, v39, s58 bitop3:0xa8
    v_cmp_ne_u32 s[6:7], 0, v20
Lk_50:
    s_or_b64 s[14:15], s[4:5], s[6:7]
    s_cbranch_scc0 Lg_44
    s_sub_u32 s64, s64, 1
    s_cbranch_scc0 Lg_43
    s_mov_b32 s64, 0
Lg_44:
    s_mov_b64 exec, -1
Lg_45:
    v_pk_add_f32 v[24:25], v[24:25], v[28:29]
    v_pk_add_f32 v[26:27], v[26:27], v[30:31]
    v_pk_fma_f32 v[32:33], v[36:37], v[204:205], v[32:33] op_sel_hi:[1,0,1]
    v_pk_fma_f32 v[34:35], v[38:39], v[204:205], v[34:35] op_sel_hi:[1,0,1]
    v_pk_add_f32 v[24:25], v[24:25], v[32:33]
    v_pk_add_f32 v[26:27], v[26:27], v[34:35]
    s_nop 0
    v_permlane16_swap_b32 v24, v25
    v_permlane16_swap_b32 v26, v27
    v_add_f32 v24, v24, v25
    v_add_f32 v26, v26, v27
    s_nop 1
    v_permlane32_swap_b32 v24, v26
    v_add_f32 v24, v24, v26
    s_nop 1
    v_add_f32_dpp v24, v24, v24 row_ror:4 row_mask:0xf bank_mask:0xf
    s_nop 1
    v_add_f32_dpp v24, v24, v24 row_ror:8 row_mask:0xf bank_mask:0xf
    s_waitcnt lgkmcnt(0)
    v_cvt_pk_bf16_f32 v24, v24, v24
    v_lshlrev_b32 v24, 16, v24
    v_add_f32 v24, v208, v24
    v_cvt_pk_bf16_f32 v24, v24, v24
    s_mov_b64 exec, s[16:17]
    buffer_store_short v24, v206, s[40:43], s19 offen
L_end:
    s_endpgm
.section .rodata,"a"
.p2align 6
.amdhsa_kernel sequential_preLN__gqa_block_cached__geglu_ffn__decode_kernel
  .amdhsa_next_free_vgpr 256
  .amdhsa_next_free_sgpr 100
  .amdhsa_accum_offset 256
  .amdhsa_group_segment_fixed_size 0
  .amdhsa_kernarg_size 96
  .amdhsa_user_sgpr_count 2
  .amdhsa_user_sgpr_kernarg_segment_ptr 1
  .amdhsa_system_sgpr_workgroup_id_x 1
  .amdhsa_float_denorm_mode_32 3
.end_amdhsa_kernel
```
